```python
import torch

def _softmax(x, axis=-1):
    return torch.softmax(x, dim=axis)
def _gelu(x):
    return torch.nn.functional.gelu(x, approximate="tanh")
def _silu(x):
    return torch.nn.functional.silu(x)
def _sigmoid(x):
    return torch.sigmoid(x)
def _layernorm(x, axis=-1, eps=1e-5):
    m = x.mean(dim=axis, keepdim=True)
    v = x.var(dim=axis, keepdim=True, unbiased=False)
    return (x - m) / torch.sqrt(v + eps)
def _scatter_add(tgt, idx, src, axis=0):
    return tgt.clone().index_add_(axis, idx, src)
def _segment_sum(src, seg, n):
    out = torch.zeros((n,) + src.shape[1:], dtype=src.dtype)
    return out.index_add_(0, seg, src)
def _pad(x, pw):
    flat = tuple(v for pair in reversed(pw) for v in pair)
    return torch.nn.functional.pad(x, flat)

kernel_name = 'concat_heads__softmax_full_mha__mha_block__prompt'

def setup_inputs():

    _w = (lambda a: (lambda t: t.to(torch.bfloat16) if t.is_floating_point() else t)(torch.as_tensor(a)))
    def _A_setup():
        B, S, D = 1, 2048, 512
        return {
            "x": _w((lambda *s: torch.randn(*s, dtype=torch.bfloat16) * 0.2)(B, S, D)),
            "wqkv": _w((lambda *s: torch.randn(*s, dtype=torch.bfloat16) * 0.2)(D, 3 * D)),
            "wo": _w((lambda *s: torch.randn(*s, dtype=torch.bfloat16) * 0.05)(D, D)),
        }
    _A_in = _A_setup()

    def _B_setup():
        B, S, D, H = 1, 2048, 512, 32
        return {
            "x": _w((lambda *s: torch.randn(*s, dtype=torch.bfloat16) * 0.2)(B, S, D)),
            "wqkv": _w((lambda *s: torch.randn(*s, dtype=torch.bfloat16) * 0.2)(D, 3 * D)),
            "wo": _w((lambda *s: torch.randn(*s, dtype=torch.bfloat16) * 0.05)(D, D)),
        }
    _B_in = _B_setup()

    return {
        "A_x": _A_in["x"],
        "A_wqkv": _A_in["wqkv"],
        "A_wo": _A_in["wo"],
        "B_x": _B_in["x"],
        "B_wqkv": _B_in["wqkv"],
        "B_wo": _B_in["wo"],
    }

def reference(A_x, A_wqkv, A_wo, B_x, B_wqkv, B_wo):
    def _A_ref(x, wqkv, wo):
        B, S, D = x.shape
        H = 32; Dh = D // H
        qkv = (lambda x, *d: x.permute(*d))((x @ wqkv).reshape(B, S, 3, H, Dh), 2, 0, 3, 1, 4)
        q, k, v = qkv[0], qkv[1], qkv[2]
        scale = Dh ** -0.5
        scores = torch.einsum("bhqd,bhkd->bhqk", q, k) * scale
        p = _softmax(scores, axis=-1)
        o = torch.einsum("bhqk,bhkd->bhqd", p, v)
        return (lambda x, *d: x.permute(*d))(o, 0, 2, 1, 3).reshape(B, S, D) @ wo

    def _B_ref(x, wqkv, wo):
        B, S, D = x.shape
        H = 32
        Dh = D // H
        qkv = (lambda x, *d: x.permute(*d))((x @ wqkv).reshape(B, S, 3, H, Dh), 2, 0, 3, 1, 4)
        q, k, v = qkv[0], qkv[1], qkv[2]
        scores = torch.einsum("bhqd,bhkd->bhqk", q, k) * (Dh ** -0.5)
        p = _softmax(scores, axis=-1)
        o = torch.einsum("bhqk,bhkd->bhqd", p, v)
        return (lambda x, *d: x.permute(*d))(o, 0, 2, 1, 3).reshape(B, S, D) @ wo

    a = _A_ref(A_x, A_wqkv, A_wo)
    b = _B_ref(B_x, B_wqkv, B_wo)
    return torch.concatenate([a, b], axis=-1)
```

```asm
; @launch grid=(256,1,1) block=(512,1,1) lds=163840
.amdgcn_target "amdgcn-amd-amdhsa--gfx950"
.text
.globl concat_heads__softmax_full_mha__mha_block__prompt_kernel
.p2align 8
.type concat_heads__softmax_full_mha__mha_block__prompt_kernel,@function
concat_heads__softmax_full_mha__mha_block__prompt_kernel:
    s_cmp_ge_u32 s2, 256
    s_cbranch_scc1 L_end
    s_load_dwordx16 s[4:19], s[0:1], 0
    s_getpc_b64 s[76:77]
L_cpf0_base:
    s_and_b32 s34, s2, 0xf8
    v_lshrrev_b32 v244, 6, v0
    v_add_u32 v244, s34, v244
    v_lshlrev_b32 v244, 7, v244
    v_min_u32 v244, L_code_end-L_cpf0_base-4, v244
    s_mov_b64 exec, 1
    global_load_dword v245, v244, s[76:77]
    s_mov_b64 exec, -1
    v_lshrrev_b32 v6, 6, v0
    v_and_b32 v1, 63, v0
    v_readfirstlane_b32 s28, v6
    s_and_b32 s34, s2, 7
    s_lshr_b32 s35, s2, 3
    s_lshr_b32 s29, s34, 2
    s_and_b32 s34, s34, 3
    s_lshl_b32 s75, s34, 2
    s_and_b32 s36, s35, 3
    s_add_u32 s31, s75, s36
    s_lshr_b32 s30, s35, 2
    s_and_b32 s32, s28, 3
    s_lshr_b32 s33, s28, 2
    v_lshlrev_b32 v2, 4, v1
    v_lshrrev_b32 v6, 3, v1
    v_and_b32 v7, 7, v1
    v_lshrrev_b32 v8, 1, v6
    v_xor_b32 v9, v7, v8
    s_lshl_b32 s34, s31, 7
    s_lshl_b32 s35, s28, 4
    s_add_u32 s34, s34, s35
    v_add_u32 v100, s34, v6
    v_lshlrev_b32 v100, 10, v100
    v_add_u32 v101, 8192, v100
    v_lshl_add_u32 v100, v9, 4, v100
    v_xor_b32 v9, 4, v9
    v_lshl_add_u32 v101, v9, 4, v101
    v_and_b32 v8, 1, v8
    s_and_b32 s34, s28, 1
    s_lshl_b32 s34, s34, 1
    v_or_b32 v8, s34, v8
    v_lshlrev_b32 v8, 1, v8
    v_xor_b32 v8, v7, v8
    s_lshl_b32 s34, s28, 3
    v_add_u32 v102, s34, v6
    v_mul_u32_u24 v102, 3072, v102
    v_lshl_add_u32 v102, v8, 4, v102
    s_lshl_b32 s34, s30, 7
    v_add_u32 v102, s34, v102
    s_mov_b32 s56, s31
    s_lshl_b32 s72, s28, 11
    s_lshl_b32 s73, s28, 10
    s_mov_b32 s70, 2097152
    s_mov_b32 s71, 0x20000
    s_mov_b32 s22, 1572864
    s_mov_b32 s23, 0x20000
    s_add_u32 s88, s56, 0
    s_and_b32 s88, s88, 7
    s_mul_i32 s89, s88, 196608
    s_lshl_b32 s88, s88, 7
    s_mov_b32 m0, s72
    s_cmp_eq_u32 s29, 0
    s_waitcnt lgkmcnt(0)
    s_cselect_b64 s[68:69], s[4:5], s[10:11]
    s_cselect_b64 s[20:21], s[6:7], s[12:13]
    s_cselect_b64 s[8:9], s[8:9], s[14:15]
    buffer_load_dwordx4 v100, s[68:71], s88 offen lds
    s_add_u32 m0, s72, 1024
    s_load_dwordx2 s[86:87], s[0:1], 64
    buffer_load_dwordx4 v101, s[68:71], s88 offen lds
    s_add_u32 m0, s73, 24576
    s_add_u32 s38, s89, 1024
    buffer_load_dwordx4 v102, s[20:23], s38 offen lds
    s_mov_b32 s44, s18
    s_and_b32 s45, s19, 0xffff
    s_mov_b32 s46, 256
    s_mov_b32 s47, 0x20000
    s_mov_b32 s48, s8
    s_and_b32 s49, s9, 0xffff
    s_mov_b32 s50, 524288
    s_mov_b32 s51, 0x20000
    s_mov_b32 s52, s16
    s_and_b32 s53, s17, 0xffff
    s_mov_b32 s54, 4194304
    s_mov_b32 s55, 0x20000
    s_lshl_b32 s35, s29, 5
    s_lshl_b32 s36, s30, 2
    s_add_u32 s65, s35, s36
    s_add_u32 s34, s65, s32
    s_lshl_b32 s34, s34, 6
    s_lshl_b32 s35, s31, 2
    s_lshl_b32 s36, s33, 1
    s_add_u32 s35, s35, s36
    s_add_u32 s34, s34, s35
    s_lshl_b32 s34, s34, 11
    s_add_u32 s78, s34, 4194304
    s_lshl_b32 s34, s29, 6
    s_add_u32 m0, s73, 32768
    s_add_u32 s38, s89, 2048
    buffer_load_dwordx4 v102, s[20:23], s38 offen lds
    s_add_u32 s34, s34, s35
    s_lshl_b32 s34, s34, 5
    s_lshl_b32 s36, s30, 2
    s_add_u32 s34, s34, s36
    s_add_u32 s34, s34, s32
    s_lshl_b32 s34, s34, 10
    s_add_u32 s81, s34, 12582912
    s_lshr_b32 s34, s28, 1
    s_add_u32 s34, s34, s65
    s_lshl_b32 s34, s34, 17
    s_and_b32 s35, s28, 1
    s_lshl_b32 s35, s35, 12
    s_add_u32 s34, s34, s35
    s_add_u32 s62, s34, 4194304
    s_lshl_b32 s63, s28, 12
    s_lshl_b32 s34, s29, 3
    s_add_u32 s34, s34, s30
    s_lshl_b32 s34, s34, 11
    s_add_u32 s79, s34, 20971520
    s_lshl_b32 s34, s31, 7
    s_add_u32 s80, s79, s34
    s_bfe_u32 s57, s30, 0x10001
    s_and_b32 s58, s30, 1
    s_lshr_b32 s34, s30, 2
    s_add_u32 m0, s73, 16384
    s_add_u32 s38, s89, 0
    buffer_load_dwordx4 v102, s[20:23], s38 offen lds
    s_lshl_b32 s34, s34, 1
    s_add_u32 s58, s58, s34
    s_lshl_b32 s34, s29, 4
    s_add_u32 s34, s34, s31
    s_lshl_b32 s34, s34, 10
    s_add_u32 s34, s34, 22020096
    s_lshl_b32 s36, s30, 7
    s_add_u32 s82, s34, s36
    s_lshl_b32 s35, s28, 7
    s_add_u32 s83, s34, s35
    s_lshl_b32 s34, s31, 2
    s_lshl_b32 s35, s57, 1
    s_add_u32 s34, s34, s35
    s_lshl_b32 s35, s29, 6
    s_add_u32 s35, s35, s34
    s_lshl_b32 s35, s35, 15
    s_add_u32 s35, s35, s63
    s_add_u32 s84, s35, 12582912
    s_add_u32 s34, s34, s33
    s_lshl_b32 s34, s34, 16
    s_lshl_b32 s35, s29, 10
    s_add_u32 s34, s34, s35
    s_lshl_b32 s35, s58, 8
    s_add_u32 s34, s34, s35
    s_barrier
    s_add_u32 s88, s56, 1
    s_and_b32 s88, s88, 7
    s_mul_i32 s89, s88, 196608
    s_lshl_b32 s88, s88, 7
    s_add_u32 m0, s72, 40960
    s_nop 0
    buffer_load_dwordx4 v100, s[68:71], s88 offen lds
    s_lshl_b32 s35, s32, 6
    s_add_u32 s85, s34, s35
    s_add_u32 s34, s75, 4
    s_and_b32 s34, s34, 15
    s_lshl_b32 s34, s34, 2
    s_lshl_b64 s[42:43], 15, s34
    s_mov_b32 s40, 0x0000ffff
    s_mov_b32 s41, 0x0000ffff
    s_getreg_b32 s59, hwreg(HW_REG_XCC_ID, 0, 4)
    s_lshl_b32 s34, s29, 14
    s_lshl_b32 s35, s31, 7
    s_add_u32 s34, s34, s35
    s_add_u32 s74, s34, 20971528
    v_and_b32 v6, 15, v1
    v_lshrrev_b32 v7, 4, v1
    v_bfe_u32 v8, v1, 1, 3
    v_xor_b32 v8, v8, v7
    s_lshl_b32 s34, s33, 13
    v_lshl_add_u32 v6, v6, 7, s34
    v_xor_b32 v9, 0, v8
    v_lshl_add_u32 v104, v9, 4, v6
    v_add_u32 v106, 81920, v104
    v_xor_b32 v9, 4, v8
    v_lshl_add_u32 v105, v9, 4, v6
    s_add_u32 m0, s72, 41984
    s_nop 0
    buffer_load_dwordx4 v101, s[68:71], s88 offen lds
    v_add_u32 v107, 81920, v105
    v_bfe_u32 v6, v1, 2, 2
    v_lshl_add_u32 v6, v7, 3, v6
    v_lshlrev_b32 v6, 7, v6
    v_bfe_u32 v8, v1, 3, 2
    v_xor_b32 v8, s32, v8
    v_lshl_add_u32 v6, v8, 5, v6
    v_and_b32 v8, 3, v1
    v_lshl_add_u32 v6, v8, 3, v6
    v_add_u32 v108, 16384, v6
    v_add_u32 v109, 98304, v6
    s_lshl_b32 s34, s32, 13
    v_add_u32 v3, s34, v2
    v_add_u32 v4, 65536, v3
    s_lshl_b32 s34, s33, 12
    v_add_u32 v230, s34, v3
    v_mov_b32 v5, 0xdddddddd
    v_and_b32 v7, 27, v1
    v_cmp_eq_u32 vcc, 16, v7
    v_mov_b32 v7, 0x3f803f80
    v_mov_b32 v238, 0
    v_cndmask_b32 v20, 0, v7, vcc
    v_cndmask_b32 v21, 0, v7, vcc
    v_cndmask_b32 v22, 0, v7, vcc
    s_add_u32 m0, s73, 65536
    s_add_u32 s38, s89, 1024
    buffer_load_dwordx4 v102, s[20:23], s38 offen lds
    v_cndmask_b32 v23, 0, v7, vcc
    v_cndmask_b32 v24, 0, v7, vcc
    v_cndmask_b32 v25, 0, v7, vcc
    v_cndmask_b32 v26, 0, v7, vcc
    v_cndmask_b32 v27, 0, v7, vcc
    v_mov_b32 v68, 0
    v_mov_b32 v69, 0
    v_mov_b32 v70, 0
    v_mov_b32 v71, 0
    v_mov_b32 v72, 0
    v_mov_b32 v73, 0
    v_mov_b32 v74, 0
    v_mov_b32 v75, 0
    v_mov_b32 v76, 0
    v_mov_b32 v77, 0
    v_mov_b32 v78, 0
    v_mov_b32 v79, 0
    v_mov_b32 v80, 0
    v_mov_b32 v81, 0
    v_mov_b32 v82, 0
    v_mov_b32 v83, 0
    v_mov_b32 v84, 0
    v_mov_b32 v85, 0
    v_mov_b32 v86, 0
    s_add_u32 m0, s73, 73728
    s_add_u32 s38, s89, 2048
    buffer_load_dwordx4 v102, s[20:23], s38 offen lds
    v_mov_b32 v87, 0
    v_mov_b32 v88, 0
    v_mov_b32 v89, 0
    v_mov_b32 v90, 0
    v_mov_b32 v91, 0
    v_mov_b32 v92, 0
    v_mov_b32 v93, 0
    v_mov_b32 v94, 0
    v_mov_b32 v95, 0
    v_mov_b32 v96, 0
    v_mov_b32 v97, 0
    v_mov_b32 v98, 0
    v_mov_b32 v99, 0
    v_lshrrev_b32 v7, 4, v1
    v_and_b32 v8, 15, v1
    v_lshlrev_b32 v9, 2, v7
    v_xor_b32 v8, v8, v9
    s_lshl_b32 s34, s28, 4
    v_add_u32 v7, s34, v7
    v_lshlrev_b32 v7, 10, v7
    v_lshl_add_u32 v7, v8, 4, v7
    s_lshl_b32 s34, s58, 8
    v_add_u32 v10, s34, v7
    v_lshrrev_b32 v7, 5, v1
    s_add_u32 m0, s73, 57344
    s_add_u32 s38, s89, 0
    buffer_load_dwordx4 v102, s[20:23], s38 offen lds
    v_bfe_u32 v8, v1, 2, 2
    v_lshl_add_u32 v7, v7, 2, v8
    v_lshlrev_b32 v7, 8, v7
    v_xor_b32 v8, s32, v8
    v_lshl_add_u32 v7, v8, 6, v7
    v_bfe_u32 v8, v1, 4, 1
    v_lshl_add_u32 v7, v8, 5, v7
    v_and_b32 v8, 3, v1
    v_lshl_add_u32 v11, v8, 3, v7
    v_add_u32 v231, 131072, v11
    v_and_b32 v6, 31, v1
    v_lshlrev_b32 v6, 11, v6
    v_lshrrev_b32 v7, 5, v1
    v_lshl_add_u32 v228, v7, 4, v6
    s_lshl_b32 s34, s33, 15
    s_add_u32 s34, s34, 65536
    v_add_u32 v229, s34, v2
    v_lshrrev_b32 v6, 2, v1
    v_lshlrev_b32 v239, 7, v6
    s_waitcnt lgkmcnt(0)
    s_mov_b32 s24, s86
    s_and_b32 s25, s87, 0xffff
    s_mov_b32 s26, 33554432
    s_mov_b32 s27, 0x20000
    s_or_b32 s34, s28, s2
    s_cmp_lg_u32 s34, 0
    s_cbranch_scc1 L_nohello
    s_memrealtime s[76:77]
    s_waitcnt lgkmcnt(0)
    s_or_b32 s76, s76, 1
    v_mov_b32 v232, s76
    v_mov_b32 v233, s77
    s_mov_b64 exec, 1
    buffer_store_dwordx2 v[232:233], v238, s[44:47], 0 offen sc1
    s_mov_b64 exec, -1
L_nohello:
    s_waitcnt vmcnt(5)
    s_barrier
    ds_read_b64_tr_b16 v[132:133], v108 offset:8192
    ds_read_b64_tr_b16 v[134:135], v108 offset:8704
    ds_read_b128 v[112:115], v104 offset:0
    ds_read_b128 v[116:119], v104 offset:2048
    ds_read_b128 v[120:123], v104 offset:4096
    ds_read_b128 v[124:127], v104 offset:6144
    ds_read_b64_tr_b16 v[136:137], v108 offset:16384
    ds_read_b64_tr_b16 v[138:139], v108 offset:16896
    ds_read_b64_tr_b16 v[128:129], v108 offset:0
    ds_read_b64_tr_b16 v[130:131], v108 offset:512
    s_waitcnt lgkmcnt(7)
    v_mfma_f32_16x16x32_bf16 v[184:187], v[132:135], v[112:115], 0
    ds_read_b64_tr_b16 v[160:161], v108 offset:12288
    s_add_u32 s88, s56, 2
    s_and_b32 s88, s88, 7
    s_mul_i32 s89, s88, 196608
    s_lshl_b32 s88, s88, 7
    s_add_u32 m0, s72, 81920
    s_nop 0
    buffer_load_dwordx4 v100, s[68:71], s88 offen lds
    s_waitcnt lgkmcnt(7)
    v_mfma_f32_16x16x32_bf16 v[188:191], v[132:135], v[116:119], 0
    ds_read_b64_tr_b16 v[162:163], v108 offset:12800
    s_waitcnt lgkmcnt(7)
    v_mfma_f32_16x16x32_bf16 v[192:195], v[132:135], v[120:123], 0
    ds_read_b128 v[140:143], v105 offset:0
    s_add_u32 m0, s72, 82944
    s_nop 0
    buffer_load_dwordx4 v101, s[68:71], s88 offen lds
    s_waitcnt lgkmcnt(7)
    v_mfma_f32_16x16x32_bf16 v[196:199], v[132:135], v[124:127], 0
    ds_read_b128 v[144:147], v105 offset:2048
    s_waitcnt lgkmcnt(6)
    v_mfma_f32_16x16x32_bf16 v[200:203], v[112:115], v[136:139], 0
    ds_read_b128 v[148:151], v105 offset:4096
    s_add_u32 m0, s73, 106496
    s_add_u32 s38, s89, 1024
    buffer_load_dwordx4 v102, s[20:23], s38 offen lds
    v_mfma_f32_16x16x32_bf16 v[204:207], v[116:119], v[136:139], 0
    ds_read_b128 v[152:155], v105 offset:6144
    v_mfma_f32_16x16x32_bf16 v[208:211], v[120:123], v[136:139], 0
    ds_read_b64_tr_b16 v[164:165], v108 offset:20480
    s_add_u32 m0, s73, 114688
    s_add_u32 s38, s89, 2048
    buffer_load_dwordx4 v102, s[20:23], s38 offen lds
    v_mfma_f32_16x16x32_bf16 v[212:215], v[124:127], v[136:139], 0
    ds_read_b64_tr_b16 v[166:167], v108 offset:20992
    s_waitcnt lgkmcnt(8)
    v_mfma_f32_16x16x32_bf16 v[168:171], v[128:131], v[112:115], 0
    ds_read_b64_tr_b16 v[156:157], v108 offset:4096
    s_add_u32 m0, s73, 98304
    s_add_u32 s38, s89, 0
    buffer_load_dwordx4 v102, s[20:23], s38 offen lds
    v_mfma_f32_16x16x32_bf16 v[172:175], v[128:131], v[116:119], 0
    ds_read_b64_tr_b16 v[158:159], v108 offset:4608
    v_mfma_f32_16x16x32_bf16 v[176:179], v[128:131], v[120:123], 0
    s_add_u32 s88, s56, 3
    s_and_b32 s88, s88, 7
    s_mul_i32 s89, s88, 196608
    s_lshl_b32 s88, s88, 7
    s_add_u32 m0, s72, 122880
    s_nop 0
    buffer_load_dwordx4 v100, s[68:71], s88 offen lds
    v_mfma_f32_16x16x32_bf16 v[180:183], v[128:131], v[124:127], 0
    s_waitcnt lgkmcnt(0)
    s_waitcnt vmcnt(6)
    s_barrier
    v_mfma_f32_16x16x32_bf16 v[184:187], v[160:163], v[140:143], v[184:187]
    ds_read_b64_tr_b16 v[132:133], v108 offset:49152
    s_add_u32 m0, s72, 123904
    s_nop 0
    buffer_load_dwordx4 v101, s[68:71], s88 offen lds
    v_mfma_f32_16x16x32_bf16 v[188:191], v[160:163], v[144:147], v[188:191]
    ds_read_b64_tr_b16 v[134:135], v108 offset:49664
    v_mfma_f32_16x16x32_bf16 v[192:195], v[160:163], v[148:151], v[192:195]
    ds_read_b128 v[112:115], v104 offset:40960
    s_add_u32 m0, s73, 147456
    s_add_u32 s38, s89, 1024
    buffer_load_dwordx4 v102, s[20:23], s38 offen lds
    v_mfma_f32_16x16x32_bf16 v[196:199], v[160:163], v[152:155], v[196:199]
    ds_read_b128 v[116:119], v104 offset:43008
    v_mfma_f32_16x16x32_bf16 v[200:203], v[140:143], v[164:167], v[200:203]
    ds_read_b128 v[120:123], v104 offset:45056
    s_add_u32 m0, s73, 155648
    s_add_u32 s38, s89, 2048
    buffer_load_dwordx4 v102, s[20:23], s38 offen lds
    v_mfma_f32_16x16x32_bf16 v[204:207], v[144:147], v[164:167], v[204:207]
    ds_read_b128 v[124:127], v104 offset:47104
    v_mfma_f32_16x16x32_bf16 v[208:211], v[148:151], v[164:167], v[208:211]
    ds_read_b64_tr_b16 v[136:137], v108 offset:57344
    s_add_u32 m0, s73, 139264
    s_add_u32 s38, s89, 0
    buffer_load_dwordx4 v102, s[20:23], s38 offen lds
    v_mfma_f32_16x16x32_bf16 v[212:215], v[152:155], v[164:167], v[212:215]
    ds_read_b64_tr_b16 v[138:139], v108 offset:57856
    v_mfma_f32_16x16x32_bf16 v[168:171], v[156:159], v[140:143], v[168:171]
    ds_read_b64_tr_b16 v[128:129], v108 offset:40960
    s_add_u32 s88, s56, 4
    s_and_b32 s88, s88, 7
    s_mul_i32 s89, s88, 196608
    s_lshl_b32 s88, s88, 7
    s_add_u32 m0, s72, 0
    s_nop 0
    buffer_load_dwordx4 v100, s[68:71], s88 offen lds
    v_mfma_f32_16x16x32_bf16 v[172:175], v[156:159], v[144:147], v[172:175]
    ds_read_b64_tr_b16 v[130:131], v108 offset:41472
    v_mfma_f32_16x16x32_bf16 v[176:179], v[156:159], v[148:151], v[176:179]
    s_add_u32 m0, s72, 1024
    s_nop 0
    buffer_load_dwordx4 v101, s[68:71], s88 offen lds
    v_mfma_f32_16x16x32_bf16 v[180:183], v[156:159], v[152:155], v[180:183]
    s_waitcnt lgkmcnt(7)
    v_mfma_f32_16x16x32_bf16 v[184:187], v[132:135], v[112:115], v[184:187]
    ds_read_b64_tr_b16 v[160:161], v108 offset:53248
    s_waitcnt lgkmcnt(7)
    v_mfma_f32_16x16x32_bf16 v[188:191], v[132:135], v[116:119], v[188:191]
    ds_read_b64_tr_b16 v[162:163], v108 offset:53760
    s_waitcnt lgkmcnt(7)
    v_mfma_f32_16x16x32_bf16 v[192:195], v[132:135], v[120:123], v[192:195]
    ds_read_b128 v[140:143], v105 offset:40960
    s_add_u32 m0, s73, 24576
    s_add_u32 s38, s89, 1024
    buffer_load_dwordx4 v102, s[20:23], s38 offen lds
    s_waitcnt lgkmcnt(7)
    v_mfma_f32_16x16x32_bf16 v[196:199], v[132:135], v[124:127], v[196:199]
    ds_read_b128 v[144:147], v105 offset:43008
    s_waitcnt lgkmcnt(6)
    v_mfma_f32_16x16x32_bf16 v[200:203], v[112:115], v[136:139], v[200:203]
    ds_read_b128 v[148:151], v105 offset:45056
    v_mfma_f32_16x16x32_bf16 v[204:207], v[116:119], v[136:139], v[204:207]
    ds_read_b128 v[152:155], v105 offset:47104
    v_mfma_f32_16x16x32_bf16 v[208:211], v[120:123], v[136:139], v[208:211]
    ds_read_b64_tr_b16 v[164:165], v108 offset:61440
    s_add_u32 m0, s73, 32768
    s_add_u32 s38, s89, 2048
    buffer_load_dwordx4 v102, s[20:23], s38 offen lds
    v_mfma_f32_16x16x32_bf16 v[212:215], v[124:127], v[136:139], v[212:215]
    ds_read_b64_tr_b16 v[166:167], v108 offset:61952
    s_waitcnt lgkmcnt(8)
    v_mfma_f32_16x16x32_bf16 v[168:171], v[128:131], v[112:115], v[168:171]
    ds_read_b64_tr_b16 v[156:157], v108 offset:45056
    v_mfma_f32_16x16x32_bf16 v[172:175], v[128:131], v[116:119], v[172:175]
    ds_read_b64_tr_b16 v[158:159], v108 offset:45568
    v_mfma_f32_16x16x32_bf16 v[176:179], v[128:131], v[120:123], v[176:179]
    s_add_u32 m0, s73, 16384
    s_add_u32 s38, s89, 0
    buffer_load_dwordx4 v102, s[20:23], s38 offen lds
    v_mfma_f32_16x16x32_bf16 v[180:183], v[128:131], v[124:127], v[180:183]
    s_waitcnt lgkmcnt(0)
    s_waitcnt vmcnt(10)
    s_barrier
    v_mfma_f32_16x16x32_bf16 v[184:187], v[160:163], v[140:143], v[184:187]
    ds_read_b64_tr_b16 v[132:133], v109 offset:8192
    s_add_u32 s88, s56, 5
    s_and_b32 s88, s88, 7
    s_mul_i32 s89, s88, 196608
    s_lshl_b32 s88, s88, 7
    s_add_u32 m0, s72, 40960
    s_nop 0
    buffer_load_dwordx4 v100, s[68:71], s88 offen lds
    v_mfma_f32_16x16x32_bf16 v[188:191], v[160:163], v[144:147], v[188:191]
    ds_read_b64_tr_b16 v[134:135], v109 offset:8704
    v_mfma_f32_16x16x32_bf16 v[192:195], v[160:163], v[148:151], v[192:195]
    ds_read_b128 v[112:115], v106 offset:0
    s_add_u32 m0, s72, 41984
    s_nop 0
    buffer_load_dwordx4 v101, s[68:71], s88 offen lds
    v_mfma_f32_16x16x32_bf16 v[196:199], v[160:163], v[152:155], v[196:199]
    ds_read_b128 v[116:119], v106 offset:2048
    v_mfma_f32_16x16x32_bf16 v[200:203], v[140:143], v[164:167], v[200:203]
    ds_read_b128 v[120:123], v106 offset:4096
    s_add_u32 m0, s73, 65536
    s_add_u32 s38, s89, 1024
    buffer_load_dwordx4 v102, s[20:23], s38 offen lds
    v_mfma_f32_16x16x32_bf16 v[204:207], v[144:147], v[164:167], v[204:207]
    ds_read_b128 v[124:127], v106 offset:6144
    v_mfma_f32_16x16x32_bf16 v[208:211], v[148:151], v[164:167], v[208:211]
    ds_read_b64_tr_b16 v[136:137], v109 offset:16384
    s_add_u32 m0, s73, 73728
    s_add_u32 s38, s89, 2048
    buffer_load_dwordx4 v102, s[20:23], s38 offen lds
    v_mfma_f32_16x16x32_bf16 v[212:215], v[152:155], v[164:167], v[212:215]
    ds_read_b64_tr_b16 v[138:139], v109 offset:16896
    v_mfma_f32_16x16x32_bf16 v[168:171], v[156:159], v[140:143], v[168:171]
    ds_read_b64_tr_b16 v[128:129], v109 offset:0
    v_mfma_f32_16x16x32_bf16 v[172:175], v[156:159], v[144:147], v[172:175]
    ds_read_b64_tr_b16 v[130:131], v109 offset:512
    v_mfma_f32_16x16x32_bf16 v[176:179], v[156:159], v[148:151], v[176:179]
    s_add_u32 m0, s73, 57344
    s_add_u32 s38, s89, 0
    buffer_load_dwordx4 v102, s[20:23], s38 offen lds
    v_mfma_f32_16x16x32_bf16 v[180:183], v[156:159], v[152:155], v[180:183]
    s_waitcnt lgkmcnt(7)
    v_mfma_f32_16x16x32_bf16 v[184:187], v[132:135], v[112:115], v[184:187]
    ds_read_b64_tr_b16 v[160:161], v109 offset:12288
    s_waitcnt lgkmcnt(7)
    v_mfma_f32_16x16x32_bf16 v[188:191], v[132:135], v[116:119], v[188:191]
    ds_read_b64_tr_b16 v[162:163], v109 offset:12800
    s_waitcnt lgkmcnt(7)
    v_mfma_f32_16x16x32_bf16 v[192:195], v[132:135], v[120:123], v[192:195]
    ds_read_b128 v[140:143], v107 offset:0
    s_waitcnt lgkmcnt(7)
    v_mfma_f32_16x16x32_bf16 v[196:199], v[132:135], v[124:127], v[196:199]
    ds_read_b128 v[144:147], v107 offset:2048
    s_waitcnt lgkmcnt(6)
    v_mfma_f32_16x16x32_bf16 v[200:203], v[112:115], v[136:139], v[200:203]
    ds_read_b128 v[148:151], v107 offset:4096
    v_mfma_f32_16x16x32_bf16 v[204:207], v[116:119], v[136:139], v[204:207]
    ds_read_b128 v[152:155], v107 offset:6144
    v_mfma_f32_16x16x32_bf16 v[208:211], v[120:123], v[136:139], v[208:211]
    ds_read_b64_tr_b16 v[164:165], v109 offset:20480
    v_mfma_f32_16x16x32_bf16 v[212:215], v[124:127], v[136:139], v[212:215]
    ds_read_b64_tr_b16 v[166:167], v109 offset:20992
    s_waitcnt lgkmcnt(8)
    v_mfma_f32_16x16x32_bf16 v[168:171], v[128:131], v[112:115], v[168:171]
    ds_read_b64_tr_b16 v[156:157], v109 offset:4096
    v_mfma_f32_16x16x32_bf16 v[172:175], v[128:131], v[116:119], v[172:175]
    ds_read_b64_tr_b16 v[158:159], v109 offset:4608
    v_mfma_f32_16x16x32_bf16 v[176:179], v[128:131], v[120:123], v[176:179]
    v_mfma_f32_16x16x32_bf16 v[180:183], v[128:131], v[124:127], v[180:183]
    s_waitcnt lgkmcnt(0)
    s_waitcnt vmcnt(10)
    s_barrier
    v_mfma_f32_16x16x32_bf16 v[184:187], v[160:163], v[140:143], v[184:187]
    ds_read_b64_tr_b16 v[132:133], v109 offset:49152
    s_add_u32 s88, s56, 6
    s_and_b32 s88, s88, 7
    s_mul_i32 s89, s88, 196608
    s_lshl_b32 s88, s88, 7
    s_add_u32 m0, s72, 81920
    s_nop 0
    buffer_load_dwordx4 v100, s[68:71], s88 offen lds
    v_mfma_f32_16x16x32_bf16 v[188:191], v[160:163], v[144:147], v[188:191]
    ds_read_b64_tr_b16 v[134:135], v109 offset:49664
    v_mfma_f32_16x16x32_bf16 v[192:195], v[160:163], v[148:151], v[192:195]
    ds_read_b128 v[112:115], v106 offset:40960
    s_add_u32 m0, s72, 82944
    s_nop 0
    buffer_load_dwordx4 v101, s[68:71], s88 offen lds
    v_mfma_f32_16x16x32_bf16 v[196:199], v[160:163], v[152:155], v[196:199]
    ds_read_b128 v[116:119], v106 offset:43008
    v_mfma_f32_16x16x32_bf16 v[200:203], v[140:143], v[164:167], v[200:203]
    ds_read_b128 v[120:123], v106 offset:45056
    s_add_u32 m0, s73, 106496
    s_add_u32 s38, s89, 1024
    buffer_load_dwordx4 v102, s[20:23], s38 offen lds
    v_mfma_f32_16x16x32_bf16 v[204:207], v[144:147], v[164:167], v[204:207]
    ds_read_b128 v[124:127], v106 offset:47104
    v_mfma_f32_16x16x32_bf16 v[208:211], v[148:151], v[164:167], v[208:211]
    ds_read_b64_tr_b16 v[136:137], v109 offset:57344
    s_add_u32 m0, s73, 114688
    s_add_u32 s38, s89, 2048
    buffer_load_dwordx4 v102, s[20:23], s38 offen lds
    v_mfma_f32_16x16x32_bf16 v[212:215], v[152:155], v[164:167], v[212:215]
    ds_read_b64_tr_b16 v[138:139], v109 offset:57856
    v_mfma_f32_16x16x32_bf16 v[168:171], v[156:159], v[140:143], v[168:171]
    ds_read_b64_tr_b16 v[128:129], v109 offset:40960
    v_mfma_f32_16x16x32_bf16 v[172:175], v[156:159], v[144:147], v[172:175]
    ds_read_b64_tr_b16 v[130:131], v109 offset:41472
    v_mfma_f32_16x16x32_bf16 v[176:179], v[156:159], v[148:151], v[176:179]
    s_add_u32 m0, s73, 98304
    s_add_u32 s38, s89, 0
    buffer_load_dwordx4 v102, s[20:23], s38 offen lds
    v_mfma_f32_16x16x32_bf16 v[180:183], v[156:159], v[152:155], v[180:183]
    s_waitcnt lgkmcnt(7)
    v_mfma_f32_16x16x32_bf16 v[184:187], v[132:135], v[112:115], v[184:187]
    ds_read_b64_tr_b16 v[160:161], v109 offset:53248
    s_waitcnt lgkmcnt(7)
    v_mfma_f32_16x16x32_bf16 v[188:191], v[132:135], v[116:119], v[188:191]
    ds_read_b64_tr_b16 v[162:163], v109 offset:53760
    s_waitcnt lgkmcnt(7)
    v_mfma_f32_16x16x32_bf16 v[192:195], v[132:135], v[120:123], v[192:195]
    ds_read_b128 v[140:143], v107 offset:40960
    s_waitcnt lgkmcnt(7)
    v_mfma_f32_16x16x32_bf16 v[196:199], v[132:135], v[124:127], v[196:199]
    ds_read_b128 v[144:147], v107 offset:43008
    s_waitcnt lgkmcnt(6)
    v_mfma_f32_16x16x32_bf16 v[200:203], v[112:115], v[136:139], v[200:203]
    ds_read_b128 v[148:151], v107 offset:45056
    v_mfma_f32_16x16x32_bf16 v[204:207], v[116:119], v[136:139], v[204:207]
    ds_read_b128 v[152:155], v107 offset:47104
    v_mfma_f32_16x16x32_bf16 v[208:211], v[120:123], v[136:139], v[208:211]
    ds_read_b64_tr_b16 v[164:165], v109 offset:61440
    v_mfma_f32_16x16x32_bf16 v[212:215], v[124:127], v[136:139], v[212:215]
    ds_read_b64_tr_b16 v[166:167], v109 offset:61952
    s_waitcnt lgkmcnt(8)
    v_mfma_f32_16x16x32_bf16 v[168:171], v[128:131], v[112:115], v[168:171]
    ds_read_b64_tr_b16 v[156:157], v109 offset:45056
    v_mfma_f32_16x16x32_bf16 v[172:175], v[128:131], v[116:119], v[172:175]
    ds_read_b64_tr_b16 v[158:159], v109 offset:45568
    v_mfma_f32_16x16x32_bf16 v[176:179], v[128:131], v[120:123], v[176:179]
    v_mfma_f32_16x16x32_bf16 v[180:183], v[128:131], v[124:127], v[180:183]
    s_waitcnt lgkmcnt(0)
    s_waitcnt vmcnt(10)
    s_barrier
    v_mfma_f32_16x16x32_bf16 v[184:187], v[160:163], v[140:143], v[184:187]
    ds_read_b64_tr_b16 v[132:133], v108 offset:8192
    s_add_u32 s88, s56, 7
    s_and_b32 s88, s88, 7
    s_mul_i32 s89, s88, 196608
    s_lshl_b32 s88, s88, 7
    s_add_u32 m0, s72, 122880
    s_nop 0
    buffer_load_dwordx4 v100, s[68:71], s88 offen lds
    v_mfma_f32_16x16x32_bf16 v[188:191], v[160:163], v[144:147], v[188:191]
    ds_read_b64_tr_b16 v[134:135], v108 offset:8704
    v_mfma_f32_16x16x32_bf16 v[192:195], v[160:163], v[148:151], v[192:195]
    ds_read_b128 v[112:115], v104 offset:0
    s_add_u32 m0, s72, 123904
    s_nop 0
    buffer_load_dwordx4 v101, s[68:71], s88 offen lds
    v_mfma_f32_16x16x32_bf16 v[196:199], v[160:163], v[152:155], v[196:199]
    ds_read_b128 v[116:119], v104 offset:2048
    v_mfma_f32_16x16x32_bf16 v[200:203], v[140:143], v[164:167], v[200:203]
    ds_read_b128 v[120:123], v104 offset:4096
    s_add_u32 m0, s73, 147456
    s_add_u32 s38, s89, 1024
    buffer_load_dwordx4 v102, s[20:23], s38 offen lds
    v_mfma_f32_16x16x32_bf16 v[204:207], v[144:147], v[164:167], v[204:207]
    ds_read_b128 v[124:127], v104 offset:6144
    v_mfma_f32_16x16x32_bf16 v[208:211], v[148:151], v[164:167], v[208:211]
    ds_read_b64_tr_b16 v[136:137], v108 offset:16384
    s_add_u32 m0, s73, 155648
    s_add_u32 s38, s89, 2048
    buffer_load_dwordx4 v102, s[20:23], s38 offen lds
    v_mfma_f32_16x16x32_bf16 v[212:215], v[152:155], v[164:167], v[212:215]
    ds_read_b64_tr_b16 v[138:139], v108 offset:16896
    v_mfma_f32_16x16x32_bf16 v[168:171], v[156:159], v[140:143], v[168:171]
    ds_read_b64_tr_b16 v[128:129], v108 offset:0
    v_mfma_f32_16x16x32_bf16 v[172:175], v[156:159], v[144:147], v[172:175]
    ds_read_b64_tr_b16 v[130:131], v108 offset:512
    v_mfma_f32_16x16x32_bf16 v[176:179], v[156:159], v[148:151], v[176:179]
    s_add_u32 m0, s73, 139264
    s_add_u32 s38, s89, 0
    buffer_load_dwordx4 v102, s[20:23], s38 offen lds
    v_mfma_f32_16x16x32_bf16 v[180:183], v[156:159], v[152:155], v[180:183]
    s_waitcnt lgkmcnt(7)
    v_mfma_f32_16x16x32_bf16 v[184:187], v[132:135], v[112:115], v[184:187]
    ds_read_b64_tr_b16 v[160:161], v108 offset:12288
    s_waitcnt lgkmcnt(7)
    v_mfma_f32_16x16x32_bf16 v[188:191], v[132:135], v[116:119], v[188:191]
    ds_read_b64_tr_b16 v[162:163], v108 offset:12800
    s_waitcnt lgkmcnt(7)
    v_mfma_f32_16x16x32_bf16 v[192:195], v[132:135], v[120:123], v[192:195]
    ds_read_b128 v[140:143], v105 offset:0
    s_waitcnt lgkmcnt(7)
    v_mfma_f32_16x16x32_bf16 v[196:199], v[132:135], v[124:127], v[196:199]
    ds_read_b128 v[144:147], v105 offset:2048
    s_waitcnt lgkmcnt(6)
    v_mfma_f32_16x16x32_bf16 v[200:203], v[112:115], v[136:139], v[200:203]
    ds_read_b128 v[148:151], v105 offset:4096
    v_mfma_f32_16x16x32_bf16 v[204:207], v[116:119], v[136:139], v[204:207]
    ds_read_b128 v[152:155], v105 offset:6144
    v_mfma_f32_16x16x32_bf16 v[208:211], v[120:123], v[136:139], v[208:211]
    ds_read_b64_tr_b16 v[164:165], v108 offset:20480
    v_mfma_f32_16x16x32_bf16 v[212:215], v[124:127], v[136:139], v[212:215]
    ds_read_b64_tr_b16 v[166:167], v108 offset:20992
    s_waitcnt lgkmcnt(8)
    v_mfma_f32_16x16x32_bf16 v[168:171], v[128:131], v[112:115], v[168:171]
    ds_read_b64_tr_b16 v[156:157], v108 offset:4096
    v_mfma_f32_16x16x32_bf16 v[172:175], v[128:131], v[116:119], v[172:175]
    ds_read_b64_tr_b16 v[158:159], v108 offset:4608
    v_mfma_f32_16x16x32_bf16 v[176:179], v[128:131], v[120:123], v[176:179]
    v_mfma_f32_16x16x32_bf16 v[180:183], v[128:131], v[124:127], v[180:183]
    s_waitcnt lgkmcnt(0)
    s_waitcnt vmcnt(10)
    s_barrier
    v_mfma_f32_16x16x32_bf16 v[184:187], v[160:163], v[140:143], v[184:187]
    ds_read_b64_tr_b16 v[132:133], v108 offset:49152
    v_mfma_f32_16x16x32_bf16 v[188:191], v[160:163], v[144:147], v[188:191]
    ds_read_b64_tr_b16 v[134:135], v108 offset:49664
    v_mfma_f32_16x16x32_bf16 v[192:195], v[160:163], v[148:151], v[192:195]
    ds_read_b128 v[112:115], v104 offset:40960
    v_mfma_f32_16x16x32_bf16 v[196:199], v[160:163], v[152:155], v[196:199]
    ds_read_b128 v[116:119], v104 offset:43008
    v_mfma_f32_16x16x32_bf16 v[200:203], v[140:143], v[164:167], v[200:203]
    ds_read_b128 v[120:123], v104 offset:45056
    buffer_load_dwordx2 v[232:233], v238, s[44:47], 0 offen sc1
    v_mfma_f32_16x16x32_bf16 v[204:207], v[144:147], v[164:167], v[204:207]
    ds_read_b128 v[124:127], v104 offset:47104
    v_mfma_f32_16x16x32_bf16 v[208:211], v[148:151], v[164:167], v[208:211]
    ds_read_b64_tr_b16 v[136:137], v108 offset:57344
    v_mfma_f32_16x16x32_bf16 v[212:215], v[152:155], v[164:167], v[212:215]
    ds_read_b64_tr_b16 v[138:139], v108 offset:57856
    v_mfma_f32_16x16x32_bf16 v[168:171], v[156:159], v[140:143], v[168:171]
    ds_read_b64_tr_b16 v[128:129], v108 offset:40960
    v_mfma_f32_16x16x32_bf16 v[172:175], v[156:159], v[144:147], v[172:175]
    ds_read_b64_tr_b16 v[130:131], v108 offset:41472
    v_mfma_f32_16x16x32_bf16 v[176:179], v[156:159], v[148:151], v[176:179]
    v_mfma_f32_16x16x32_bf16 v[180:183], v[156:159], v[152:155], v[180:183]
    s_waitcnt lgkmcnt(7)
    v_mfma_f32_16x16x32_bf16 v[184:187], v[132:135], v[112:115], v[184:187]
    ds_read_b64_tr_b16 v[160:161], v108 offset:53248
    s_waitcnt lgkmcnt(7)
    v_mfma_f32_16x16x32_bf16 v[188:191], v[132:135], v[116:119], v[188:191]
    ds_read_b64_tr_b16 v[162:163], v108 offset:53760
    s_waitcnt lgkmcnt(7)
    v_mfma_f32_16x16x32_bf16 v[192:195], v[132:135], v[120:123], v[192:195]
    ds_read_b128 v[140:143], v105 offset:40960
    s_waitcnt lgkmcnt(7)
    v_mfma_f32_16x16x32_bf16 v[196:199], v[132:135], v[124:127], v[196:199]
    ds_read_b128 v[144:147], v105 offset:43008
    s_waitcnt lgkmcnt(6)
    v_mfma_f32_16x16x32_bf16 v[200:203], v[112:115], v[136:139], v[200:203]
    ds_read_b128 v[148:151], v105 offset:45056
    v_mfma_f32_16x16x32_bf16 v[204:207], v[116:119], v[136:139], v[204:207]
    ds_read_b128 v[152:155], v105 offset:47104
    v_mfma_f32_16x16x32_bf16 v[208:211], v[120:123], v[136:139], v[208:211]
    ds_read_b64_tr_b16 v[164:165], v108 offset:61440
    v_mfma_f32_16x16x32_bf16 v[212:215], v[124:127], v[136:139], v[212:215]
    ds_read_b64_tr_b16 v[166:167], v108 offset:61952
    s_waitcnt lgkmcnt(8)
    v_mfma_f32_16x16x32_bf16 v[168:171], v[128:131], v[112:115], v[168:171]
    ds_read_b64_tr_b16 v[156:157], v108 offset:45056
    v_mfma_f32_16x16x32_bf16 v[172:175], v[128:131], v[116:119], v[172:175]
    ds_read_b64_tr_b16 v[158:159], v108 offset:45568
    v_mfma_f32_16x16x32_bf16 v[176:179], v[128:131], v[120:123], v[176:179]
    v_mfma_f32_16x16x32_bf16 v[180:183], v[128:131], v[124:127], v[180:183]
    s_waitcnt lgkmcnt(0)
    s_waitcnt vmcnt(6)
    s_barrier
    v_mfma_f32_16x16x32_bf16 v[184:187], v[160:163], v[140:143], v[184:187]
    ds_read_b64_tr_b16 v[132:133], v109 offset:8192
    v_mfma_f32_16x16x32_bf16 v[188:191], v[160:163], v[144:147], v[188:191]
    ds_read_b64_tr_b16 v[134:135], v109 offset:8704
    v_mfma_f32_16x16x32_bf16 v[192:195], v[160:163], v[148:151], v[192:195]
    ds_read_b128 v[112:115], v106 offset:0
    v_mfma_f32_16x16x32_bf16 v[196:199], v[160:163], v[152:155], v[196:199]
    ds_read_b128 v[116:119], v106 offset:2048
    v_mfma_f32_16x16x32_bf16 v[200:203], v[140:143], v[164:167], v[200:203]
    ds_read_b128 v[120:123], v106 offset:4096
    v_mfma_f32_16x16x32_bf16 v[204:207], v[144:147], v[164:167], v[204:207]
    ds_read_b128 v[124:127], v106 offset:6144
    v_mfma_f32_16x16x32_bf16 v[208:211], v[148:151], v[164:167], v[208:211]
    ds_read_b64_tr_b16 v[136:137], v109 offset:16384
    v_mfma_f32_16x16x32_bf16 v[212:215], v[152:155], v[164:167], v[212:215]
    ds_read_b64_tr_b16 v[138:139], v109 offset:16896
    v_mfma_f32_16x16x32_bf16 v[168:171], v[156:159], v[140:143], v[168:171]
    ds_read_b64_tr_b16 v[128:129], v109 offset:0
    v_mfma_f32_16x16x32_bf16 v[172:175], v[156:159], v[144:147], v[172:175]
    ds_read_b64_tr_b16 v[130:131], v109 offset:512
    v_mfma_f32_16x16x32_bf16 v[176:179], v[156:159], v[148:151], v[176:179]
    v_mfma_f32_16x16x32_bf16 v[180:183], v[156:159], v[152:155], v[180:183]
    s_waitcnt lgkmcnt(7)
    v_mfma_f32_16x16x32_bf16 v[184:187], v[132:135], v[112:115], v[184:187]
    ds_read_b64_tr_b16 v[160:161], v109 offset:12288
    s_waitcnt lgkmcnt(7)
    v_mfma_f32_16x16x32_bf16 v[188:191], v[132:135], v[116:119], v[188:191]
    ds_read_b64_tr_b16 v[162:163], v109 offset:12800
    s_waitcnt lgkmcnt(7)
    v_mfma_f32_16x16x32_bf16 v[192:195], v[132:135], v[120:123], v[192:195]
    ds_read_b128 v[140:143], v107 offset:0
    s_waitcnt lgkmcnt(7)
    v_mfma_f32_16x16x32_bf16 v[196:199], v[132:135], v[124:127], v[196:199]
    ds_read_b128 v[144:147], v107 offset:2048
    s_waitcnt lgkmcnt(6)
    v_mfma_f32_16x16x32_bf16 v[200:203], v[112:115], v[136:139], v[200:203]
    ds_read_b128 v[148:151], v107 offset:4096
    v_mfma_f32_16x16x32_bf16 v[204:207], v[116:119], v[136:139], v[204:207]
    ds_read_b128 v[152:155], v107 offset:6144
    v_mfma_f32_16x16x32_bf16 v[208:211], v[120:123], v[136:139], v[208:211]
    ds_read_b64_tr_b16 v[164:165], v109 offset:20480
    v_mfma_f32_16x16x32_bf16 v[212:215], v[124:127], v[136:139], v[212:215]
    ds_read_b64_tr_b16 v[166:167], v109 offset:20992
    s_waitcnt lgkmcnt(8)
    v_mfma_f32_16x16x32_bf16 v[168:171], v[128:131], v[112:115], v[168:171]
    ds_read_b64_tr_b16 v[156:157], v109 offset:4096
    v_mfma_f32_16x16x32_bf16 v[172:175], v[128:131], v[116:119], v[172:175]
    ds_read_b64_tr_b16 v[158:159], v109 offset:4608
    v_mfma_f32_16x16x32_bf16 v[176:179], v[128:131], v[120:123], v[176:179]
    v_mfma_f32_16x16x32_bf16 v[180:183], v[128:131], v[124:127], v[180:183]
    s_waitcnt lgkmcnt(0)
    s_waitcnt vmcnt(0)
    s_barrier
    v_mfma_f32_16x16x32_bf16 v[184:187], v[160:163], v[140:143], v[184:187]
    ds_read_b64_tr_b16 v[132:133], v109 offset:49152
    v_mfma_f32_16x16x32_bf16 v[188:191], v[160:163], v[144:147], v[188:191]
    ds_read_b64_tr_b16 v[134:135], v109 offset:49664
    v_mfma_f32_16x16x32_bf16 v[192:195], v[160:163], v[148:151], v[192:195]
    ds_read_b128 v[112:115], v106 offset:40960
    v_mfma_f32_16x16x32_bf16 v[196:199], v[160:163], v[152:155], v[196:199]
    ds_read_b128 v[116:119], v106 offset:43008
    v_mfma_f32_16x16x32_bf16 v[200:203], v[140:143], v[164:167], v[200:203]
    ds_read_b128 v[120:123], v106 offset:45056
    v_mfma_f32_16x16x32_bf16 v[204:207], v[144:147], v[164:167], v[204:207]
    ds_read_b128 v[124:127], v106 offset:47104
    v_mfma_f32_16x16x32_bf16 v[208:211], v[148:151], v[164:167], v[208:211]
    ds_read_b64_tr_b16 v[136:137], v109 offset:57344
    v_mfma_f32_16x16x32_bf16 v[212:215], v[152:155], v[164:167], v[212:215]
    ds_read_b64_tr_b16 v[138:139], v109 offset:57856
    v_mfma_f32_16x16x32_bf16 v[168:171], v[156:159], v[140:143], v[168:171]
    ds_read_b64_tr_b16 v[128:129], v109 offset:40960
    v_mfma_f32_16x16x32_bf16 v[172:175], v[156:159], v[144:147], v[172:175]
    ds_read_b64_tr_b16 v[130:131], v109 offset:41472
    v_mfma_f32_16x16x32_bf16 v[176:179], v[156:159], v[148:151], v[176:179]
    v_mfma_f32_16x16x32_bf16 v[180:183], v[156:159], v[152:155], v[180:183]
    s_waitcnt lgkmcnt(7)
    v_mfma_f32_16x16x32_bf16 v[184:187], v[132:135], v[112:115], v[184:187]
    ds_read_b64_tr_b16 v[160:161], v109 offset:53248
    v_readfirstlane_b32 s60, v232
    s_waitcnt lgkmcnt(7)
    v_mfma_f32_16x16x32_bf16 v[188:191], v[132:135], v[116:119], v[188:191]
    ds_read_b64_tr_b16 v[162:163], v109 offset:53760
    v_readfirstlane_b32 s61, v233
    s_waitcnt lgkmcnt(7)
    v_mfma_f32_16x16x32_bf16 v[192:195], v[132:135], v[120:123], v[192:195]
    ds_read_b128 v[140:143], v107 offset:40960
    s_mov_b32 s36, 1052289595
    s_waitcnt lgkmcnt(7)
    v_mfma_f32_16x16x32_bf16 v[196:199], v[132:135], v[124:127], v[196:199]
    ds_read_b128 v[144:147], v107 offset:43008
    s_mov_b32 s37, 1052289595
    s_waitcnt lgkmcnt(6)
    v_mfma_f32_16x16x32_bf16 v[200:203], v[112:115], v[136:139], v[200:203]
    ds_read_b128 v[148:151], v107 offset:45056
    s_mov_b32 s38, 0
    v_mfma_f32_16x16x32_bf16 v[204:207], v[116:119], v[136:139], v[204:207]
    ds_read_b128 v[152:155], v107 offset:47104
    v_mfma_f32_16x16x32_bf16 v[208:211], v[120:123], v[136:139], v[208:211]
    ds_read_b64_tr_b16 v[164:165], v109 offset:61440
    v_mfma_f32_16x16x32_bf16 v[212:215], v[124:127], v[136:139], v[212:215]
    ds_read_b64_tr_b16 v[166:167], v109 offset:61952
    ds_read_b64_tr_b16 v[156:157], v109 offset:45056
    ds_read_b64_tr_b16 v[158:159], v109 offset:45568
    s_waitcnt lgkmcnt(7)
    v_mfma_f32_16x16x32_bf16 v[184:187], v[160:163], v[140:143], v[184:187]
    s_waitcnt lgkmcnt(6)
    v_mfma_f32_16x16x32_bf16 v[188:191], v[160:163], v[144:147], v[188:191]
    s_waitcnt lgkmcnt(5)
    v_mfma_f32_16x16x32_bf16 v[192:195], v[160:163], v[148:151], v[192:195]
    s_waitcnt lgkmcnt(4)
    v_mfma_f32_16x16x32_bf16 v[196:199], v[160:163], v[152:155], v[196:199]
    s_waitcnt lgkmcnt(2)
    v_mfma_f32_16x16x32_bf16 v[200:203], v[140:143], v[164:167], v[200:203]
    v_mfma_f32_16x16x32_bf16 v[204:207], v[144:147], v[164:167], v[204:207]
    v_mfma_f32_16x16x32_bf16 v[208:211], v[148:151], v[164:167], v[208:211]
    v_mfma_f32_16x16x32_bf16 v[212:215], v[152:155], v[164:167], v[212:215]
    s_waitcnt lgkmcnt(0)
    v_mfma_f32_16x16x32_bf16 v[168:171], v[128:131], v[112:115], v[168:171]
    v_cvt_pk_bf16_f32 v36, v184, v185
    v_cvt_pk_bf16_f32 v37, v186, v187
    v_mfma_f32_16x16x32_bf16 v[172:175], v[128:131], v[116:119], v[172:175]
    v_cvt_pk_bf16_f32 v38, v188, v189
    v_cvt_pk_bf16_f32 v39, v190, v191
    v_mfma_f32_16x16x32_bf16 v[176:179], v[128:131], v[120:123], v[176:179]
    v_cvt_pk_bf16_f32 v44, v192, v193
    v_cvt_pk_bf16_f32 v45, v194, v195
    v_mfma_f32_16x16x32_bf16 v[180:183], v[128:131], v[124:127], v[180:183]
    v_cvt_pk_bf16_f32 v46, v196, v197
    v_cvt_pk_bf16_f32 v47, v198, v199
    v_mfma_f32_16x16x32_bf16 v[168:171], v[156:159], v[140:143], v[168:171]
    v_permlane16_swap_b32 v36, v38
    v_permlane16_swap_b32 v37, v39
    v_permlane16_swap_b32 v44, v46
    v_permlane16_swap_b32 v45, v47
    v_mfma_f32_16x16x32_bf16 v[172:175], v[156:159], v[144:147], v[172:175]
    buffer_store_dwordx4 v[36:39], v2, s[24:27], s78 offen offset:0 sc1
    ds_write_b128 v230, v[36:39] offset:0
    buffer_store_dwordx4 v[44:47], v2, s[24:27], s78 offen offset:2048 sc1
    ds_write_b128 v230, v[44:47] offset:2048
    v_mfma_f32_16x16x32_bf16 v[176:179], v[156:159], v[148:151], v[176:179]
    v_cvt_pk_bf16_f32 v40, v200, v201
    v_cvt_pk_bf16_f32 v41, v202, v203
    v_cvt_pk_bf16_f32 v42, v204, v205
    v_cvt_pk_bf16_f32 v43, v206, v207
    v_mfma_f32_16x16x32_bf16 v[180:183], v[156:159], v[152:155], v[180:183]
    v_cvt_pk_bf16_f32 v48, v208, v209
    v_cvt_pk_bf16_f32 v49, v210, v211
    v_cvt_pk_bf16_f32 v50, v212, v213
    v_cvt_pk_bf16_f32 v51, v214, v215
    v_permlane16_swap_b32 v40, v42
    v_permlane16_swap_b32 v41, v43
    v_permlane16_swap_b32 v48, v50
    v_permlane16_swap_b32 v49, v51
    buffer_store_dwordx4 v[40:43], v2, s[24:27], s78 offen offset:1024 sc1
    ds_write_b128 v230, v[40:43] offset:1024
    buffer_store_dwordx4 v[48:51], v2, s[24:27], s78 offen offset:3072 sc1
    ds_write_b128 v230, v[48:51] offset:3072
L_tagwait:
    s_cmp_lg_u32 s60, 0
    s_cbranch_scc0 L_tagpoll
L_tagok:
    v_pk_mul_f32 v[168:169], s[36:37], v[168:169]
    v_pk_mul_f32 v[170:171], s[36:37], v[170:171]
    v_pk_mul_f32 v[172:173], s[36:37], v[172:173]
    v_pk_mul_f32 v[174:175], s[36:37], v[174:175]
    v_pk_mul_f32 v[176:177], s[36:37], v[176:177]
    v_pk_mul_f32 v[178:179], s[36:37], v[178:179]
    v_pk_mul_f32 v[180:181], s[36:37], v[180:181]
    v_pk_mul_f32 v[182:183], s[36:37], v[182:183]
    v_cvt_pk_bf16_f32 v28, v168, v169
    v_cvt_pk_bf16_f32 v29, v170, v171
    v_cvt_pk_bf16_f32 v30, v172, v173
    v_cvt_pk_bf16_f32 v31, v174, v175
    v_cvt_pk_bf16_f32 v32, v176, v177
    v_cvt_pk_bf16_f32 v33, v178, v179
    v_cvt_pk_bf16_f32 v34, v180, v181
    v_cvt_pk_bf16_f32 v35, v182, v183
    v_mov_b32 v240, s60
    v_mov_b32 v241, s61
    s_add_u32 s59, s59, s61
    v_mov_b32 v242, s60
    v_mov_b32 v243, s59
    v_permlane16_swap_b32 v28, v30
    v_permlane16_swap_b32 v29, v31
    v_permlane16_swap_b32 v32, v34
    v_permlane16_swap_b32 v33, v35
    s_setprio 3
    s_waitcnt lgkmcnt(0)
    s_barrier
    ds_read_b128 v[12:15], v3 offset:0
    ds_read_b128 v[16:19], v3 offset:2048
    s_mov_b64 exec, s[40:41]
    ds_read_b128 v[20:23], v3 offset:1024
    s_mov_b64 exec, -1
    s_waitcnt lgkmcnt(2)
    v_mfma_f32_32x32x16_bf16 v[36:51], v[12:15], v[28:31], 0
    s_nop 11
    v_exp_f32 v36, v36
    v_exp_f32 v37, v37
    v_exp_f32 v38, v38
    s_mov_b64 exec, s[40:41]
    ds_read_b128 v[24:27], v3 offset:1280
    s_mov_b64 exec, -1
    v_exp_f32 v39, v39
    v_exp_f32 v40, v40
    v_exp_f32 v41, v41
    v_mfma_f32_32x32x16_bf16 v[52:67], v[12:15], v[32:35], 0
    s_waitcnt lgkmcnt(1)
    v_exp_f32 v42, v42
    v_exp_f32 v43, v43
    v_exp_f32 v44, v44
    v_exp_f32 v45, v45
    v_exp_f32 v46, v46
    v_smfmac_f32_32x32x32_bf16 v[68:83], v[20:23], v[36:43], v5
    s_waitcnt lgkmcnt(0)
    ds_read_b128 v[12:15], v3 offset:4096
    v_exp_f32 v47, v47
    v_exp_f32 v48, v48
    v_exp_f32 v49, v49
    v_exp_f32 v50, v50
    v_exp_f32 v51, v51
    v_exp_f32 v52, v52
    v_exp_f32 v53, v53
    v_exp_f32 v54, v54
    v_smfmac_f32_32x32x32_bf16 v[68:83], v[24:27], v[44:51], v5
    s_setprio 2
    v_exp_f32 v55, v55
    v_exp_f32 v56, v56
    v_exp_f32 v57, v57
    v_mfma_f32_32x32x16_bf16 v[36:51], v[16:19], v[28:31], 0
    v_exp_f32 v58, v58
    v_exp_f32 v59, v59
    v_exp_f32 v60, v60
    v_exp_f32 v61, v61
    v_exp_f32 v62, v62
    v_smfmac_f32_32x32x32_bf16 v[84:99], v[20:23], v[52:59], v5
    s_mov_b64 exec, s[40:41]
    ds_read_b128 v[20:23], v3 offset:3072
    s_mov_b64 exec, -1
    v_exp_f32 v63, v63
    v_exp_f32 v64, v64
    v_exp_f32 v65, v65
    v_exp_f32 v66, v66
    v_exp_f32 v67, v67
    v_exp_f32 v36, v36
    v_exp_f32 v37, v37
    v_exp_f32 v38, v38
    v_smfmac_f32_32x32x32_bf16 v[84:99], v[24:27], v[60:67], v5
    s_mov_b64 exec, s[40:41]
    ds_read_b128 v[24:27], v3 offset:3328
    s_mov_b64 exec, -1
    v_exp_f32 v39, v39
    v_exp_f32 v40, v40
    v_exp_f32 v41, v41
    v_mfma_f32_32x32x16_bf16 v[52:67], v[16:19], v[32:35], 0
    s_waitcnt lgkmcnt(1)
    v_exp_f32 v42, v42
    v_exp_f32 v43, v43
    v_exp_f32 v44, v44
    v_exp_f32 v45, v45
    v_exp_f32 v46, v46
    v_smfmac_f32_32x32x32_bf16 v[68:83], v[20:23], v[36:43], v5
    s_waitcnt lgkmcnt(0)
    s_waitcnt vmcnt(0)
    s_cmp_lg_u32 s28, 0
    s_barrier
    s_cbranch_scc1 L_flag_done
    s_mov_b64 exec, 1
    buffer_store_dwordx4 v[240:243], v238, s[24:27], s80 offen sc1
    s_mov_b64 exec, -1
L_flag_done:
    ds_read_b128 v[16:19], v3 offset:6144
    v_exp_f32 v47, v47
    v_exp_f32 v48, v48
    v_exp_f32 v49, v49
    v_exp_f32 v50, v50
    v_exp_f32 v51, v51
    v_exp_f32 v52, v52
    v_exp_f32 v53, v53
    v_exp_f32 v54, v54
    v_smfmac_f32_32x32x32_bf16 v[68:83], v[24:27], v[44:51], v5
    s_setprio 1
    v_exp_f32 v55, v55
    v_exp_f32 v56, v56
    v_exp_f32 v57, v57
    v_mfma_f32_32x32x16_bf16 v[36:51], v[12:15], v[28:31], 0
    v_exp_f32 v58, v58
    v_exp_f32 v59, v59
    v_exp_f32 v60, v60
    v_exp_f32 v61, v61
    v_exp_f32 v62, v62
    v_smfmac_f32_32x32x32_bf16 v[84:99], v[20:23], v[52:59], v5
    s_mov_b64 exec, s[40:41]
    ds_read_b128 v[20:23], v3 offset:5120
    s_mov_b64 exec, -1
    v_exp_f32 v63, v63
    v_exp_f32 v64, v64
    v_exp_f32 v65, v65
    v_exp_f32 v66, v66
    v_exp_f32 v67, v67
    v_exp_f32 v36, v36
    v_exp_f32 v37, v37
    v_exp_f32 v38, v38
    v_smfmac_f32_32x32x32_bf16 v[84:99], v[24:27], v[60:67], v5
    s_mov_b64 exec, s[40:41]
    ds_read_b128 v[24:27], v3 offset:5376
    s_mov_b64 exec, -1
    v_exp_f32 v39, v39
    v_exp_f32 v40, v40
    v_exp_f32 v41, v41
    v_mfma_f32_32x32x16_bf16 v[52:67], v[12:15], v[32:35], 0
    s_waitcnt lgkmcnt(1)
    v_exp_f32 v42, v42
    v_exp_f32 v43, v43
    v_exp_f32 v44, v44
    v_exp_f32 v45, v45
    v_exp_f32 v46, v46
    v_smfmac_f32_32x32x32_bf16 v[68:83], v[20:23], v[36:43], v5
    s_waitcnt lgkmcnt(0)
    v_exp_f32 v47, v47
    v_exp_f32 v48, v48
    v_exp_f32 v49, v49
    v_exp_f32 v50, v50
    v_exp_f32 v51, v51
    v_exp_f32 v52, v52
    v_exp_f32 v53, v53
    v_exp_f32 v54, v54
    v_smfmac_f32_32x32x32_bf16 v[68:83], v[24:27], v[44:51], v5
    s_setprio 0
    buffer_load_dwordx2 v[232:233], v239, s[24:27], s79 offen sc1
    v_exp_f32 v55, v55
    v_exp_f32 v56, v56
    v_exp_f32 v57, v57
    v_mfma_f32_32x32x16_bf16 v[36:51], v[16:19], v[28:31], 0
    v_exp_f32 v58, v58
    v_exp_f32 v59, v59
    v_exp_f32 v60, v60
    v_exp_f32 v61, v61
    v_exp_f32 v62, v62
    v_smfmac_f32_32x32x32_bf16 v[84:99], v[20:23], v[52:59], v5
    s_mov_b64 exec, s[40:41]
    ds_read_b128 v[20:23], v3 offset:7168
    s_mov_b64 exec, -1
    v_exp_f32 v63, v63
    v_exp_f32 v64, v64
    v_exp_f32 v65, v65
    v_exp_f32 v66, v66
    v_exp_f32 v67, v67
    v_exp_f32 v36, v36
    v_exp_f32 v37, v37
    v_exp_f32 v38, v38
    v_smfmac_f32_32x32x32_bf16 v[84:99], v[24:27], v[60:67], v5
    s_waitcnt vmcnt(0)
    s_mov_b32 s38, 0
L_pollkv1:
    v_cmp_ne_u64 vcc, s[60:61], v[232:233]
    s_mov_b64 s[88:89], vcc
    s_and_b64 vcc, vcc, s[42:43]
    s_cbranch_vccz L_pollkv1_ok
    s_add_u32 s38, s38, 1
    s_cmp_ge_u32 s38, 2097152
    s_cbranch_scc1 L_pollkv1_ok
    buffer_load_dwordx2 v[232:233], v239, s[24:27], s79 offen sc1
    s_waitcnt vmcnt(0)
    s_branch L_pollkv1
L_pollkv1_ok:
    s_add_u32 m0, s63, 32768
    s_add_u32 s86, s75, 4
    s_and_b32 s86, s86, 15
    s_lshl_b32 s86, s86, 13
    s_add_u32 s86, s86, s62
    buffer_load_dwordx4 v2, s[24:27], s86 offen offset:0 sc1 lds
    buffer_load_dwordx4 v2, s[24:27], s86 offen offset:1024 sc1 lds
    buffer_load_dwordx4 v2, s[24:27], s86 offen offset:2048 sc1 lds
    buffer_load_dwordx4 v2, s[24:27], s86 offen offset:3072 sc1 lds
    s_add_u32 s86, s75, 5
    s_and_b32 s86, s86, 15
    s_lshl_b32 s86, s86, 13
    s_add_u32 s86, s86, s62
    s_mov_b64 exec, s[40:41]
    ds_read_b128 v[24:27], v3 offset:7424
    s_mov_b64 exec, -1
    v_exp_f32 v39, v39
    v_exp_f32 v40, v40
    v_exp_f32 v41, v41
    v_mfma_f32_32x32x16_bf16 v[52:67], v[16:19], v[32:35], 0
    s_waitcnt lgkmcnt(1)
    v_exp_f32 v42, v42
    v_exp_f32 v43, v43
    v_exp_f32 v44, v44
    v_exp_f32 v45, v45
    v_exp_f32 v46, v46
    v_smfmac_f32_32x32x32_bf16 v[68:83], v[20:23], v[36:43], v5
    s_waitcnt lgkmcnt(0)
    v_exp_f32 v47, v47
    v_exp_f32 v48, v48
    v_exp_f32 v49, v49
    v_exp_f32 v50, v50
    v_exp_f32 v51, v51
    v_exp_f32 v52, v52
    v_exp_f32 v53, v53
    v_exp_f32 v54, v54
    v_smfmac_f32_32x32x32_bf16 v[68:83], v[24:27], v[44:51], v5
    v_exp_f32 v55, v55
    v_exp_f32 v56, v56
    v_exp_f32 v57, v57
    v_exp_f32 v58, v58
    v_exp_f32 v59, v59
    v_exp_f32 v60, v60
    v_exp_f32 v61, v61
    v_exp_f32 v62, v62
    v_smfmac_f32_32x32x32_bf16 v[84:99], v[20:23], v[52:59], v5
    v_exp_f32 v63, v63
    v_exp_f32 v64, v64
    v_exp_f32 v65, v65
    v_exp_f32 v66, v66
    v_exp_f32 v67, v67
    s_nop 2
    v_smfmac_f32_32x32x32_bf16 v[84:99], v[24:27], v[60:67], v5
    s_cmp_eq_u64 s[88:89], 0
    s_cbranch_scc1 L_polled
    buffer_load_dwordx2 v[232:233], v239, s[24:27], s79 offen sc1
    s_waitcnt vmcnt(0)
    s_mov_b32 s38, 0
L_pollkv:
    v_cmp_ne_u64 vcc, s[60:61], v[232:233]
    s_cbranch_vccz L_pollkv_ok
    s_add_u32 s38, s38, 1
    s_cmp_ge_u32 s38, 2097152
    s_cbranch_scc1 L_pollkv_ok
    buffer_load_dwordx2 v[232:233], v239, s[24:27], s79 offen sc1
    s_waitcnt vmcnt(0)
    s_branch L_pollkv
L_pollkv_ok:
L_polled:
    s_setprio 1
    s_waitcnt vmcnt(0)
    s_barrier
    ds_read_b128 v[12:15], v3 offset:32768
    ds_read_b128 v[16:19], v3 offset:34816
    s_mov_b64 exec, s[40:41]
    ds_read_b128 v[20:23], v3 offset:33792
    s_mov_b64 exec, -1
    s_waitcnt lgkmcnt(2)
    v_mfma_f32_32x32x16_bf16 v[36:51], v[12:15], v[28:31], 0
    s_nop 11
    v_exp_f32 v36, v36
    v_exp_f32 v37, v37
    v_exp_f32 v38, v38
    s_add_u32 m0, s63, 65536
    s_mov_b64 exec, s[40:41]
    ds_read_b128 v[24:27], v3 offset:34048
    s_mov_b64 exec, -1
    v_exp_f32 v39, v39
    v_exp_f32 v40, v40
    v_exp_f32 v41, v41
    v_mfma_f32_32x32x16_bf16 v[52:67], v[12:15], v[32:35], 0
    s_waitcnt lgkmcnt(1)
    buffer_load_dwordx4 v2, s[24:27], s86 offen offset:0 sc1 lds
    v_exp_f32 v42, v42
    v_exp_f32 v43, v43
    v_exp_f32 v44, v44
    v_exp_f32 v45, v45
    v_exp_f32 v46, v46
    v_smfmac_f32_32x32x32_bf16 v[68:83], v[20:23], v[36:43], v5
    s_waitcnt lgkmcnt(0)
    buffer_load_dwordx4 v2, s[24:27], s86 offen offset:1024 sc1 lds
    ds_read_b128 v[12:15], v3 offset:36864
    v_exp_f32 v47, v47
    v_exp_f32 v48, v48
    v_exp_f32 v49, v49
    v_exp_f32 v50, v50
    v_exp_f32 v51, v51
    v_exp_f32 v52, v52
    v_exp_f32 v53, v53
    v_exp_f32 v54, v54
    v_smfmac_f32_32x32x32_bf16 v[68:83], v[24:27], v[44:51], v5
    s_setprio 0
    buffer_load_dwordx4 v2, s[24:27], s86 offen offset:2048 sc1 lds
    v_exp_f32 v55, v55
    v_exp_f32 v56, v56
    v_exp_f32 v57, v57
    v_mfma_f32_32x32x16_bf16 v[36:51], v[16:19], v[28:31], 0
    buffer_load_dwordx4 v2, s[24:27], s86 offen offset:3072 sc1 lds
    v_exp_f32 v58, v58
    v_exp_f32 v59, v59
    v_exp_f32 v60, v60
    v_exp_f32 v61, v61
    v_exp_f32 v62, v62
    v_smfmac_f32_32x32x32_bf16 v[84:99], v[20:23], v[52:59], v5
    s_mov_b64 exec, s[40:41]
    ds_read_b128 v[20:23], v3 offset:35840
    s_mov_b64 exec, -1
    v_exp_f32 v63, v63
    v_exp_f32 v64, v64
    v_exp_f32 v65, v65
    v_exp_f32 v66, v66
    v_exp_f32 v67, v67
    v_exp_f32 v36, v36
    v_exp_f32 v37, v37
    v_exp_f32 v38, v38
    v_smfmac_f32_32x32x32_bf16 v[84:99], v[24:27], v[60:67], v5
    s_add_u32 s86, s75, 6
    s_and_b32 s86, s86, 15
    s_lshl_b32 s86, s86, 13
    s_add_u32 s86, s86, s62
    s_add_u32 m0, s63, 98304
    s_mov_b64 exec, s[40:41]
    ds_read_b128 v[24:27], v3 offset:36096
    s_mov_b64 exec, -1
    v_exp_f32 v39, v39
    v_exp_f32 v40, v40
    v_exp_f32 v41, v41
    v_mfma_f32_32x32x16_bf16 v[52:67], v[16:19], v[32:35], 0
    s_waitcnt lgkmcnt(1)
    buffer_load_dwordx4 v2, s[24:27], s86 offen offset:0 sc1 lds
    v_exp_f32 v42, v42
    v_exp_f32 v43, v43
    v_exp_f32 v44, v44
    v_exp_f32 v45, v45
    v_exp_f32 v46, v46
    v_smfmac_f32_32x32x32_bf16 v[68:83], v[20:23], v[36:43], v5
    s_waitcnt lgkmcnt(0)
    buffer_load_dwordx4 v2, s[24:27], s86 offen offset:1024 sc1 lds
    ds_read_b128 v[16:19], v3 offset:38912
    v_exp_f32 v47, v47
    v_exp_f32 v48, v48
    v_exp_f32 v49, v49
    v_exp_f32 v50, v50
    v_exp_f32 v51, v51
    v_exp_f32 v52, v52
    v_exp_f32 v53, v53
    v_exp_f32 v54, v54
    v_smfmac_f32_32x32x32_bf16 v[68:83], v[24:27], v[44:51], v5
    buffer_load_dwordx4 v2, s[24:27], s86 offen offset:2048 sc1 lds
    v_exp_f32 v55, v55
    v_exp_f32 v56, v56
    v_exp_f32 v57, v57
    v_mfma_f32_32x32x16_bf16 v[36:51], v[12:15], v[28:31], 0
    buffer_load_dwordx4 v2, s[24:27], s86 offen offset:3072 sc1 lds
    v_exp_f32 v58, v58
    v_exp_f32 v59, v59
    v_exp_f32 v60, v60
    v_exp_f32 v61, v61
    v_exp_f32 v62, v62
    v_smfmac_f32_32x32x32_bf16 v[84:99], v[20:23], v[52:59], v5
    s_mov_b64 exec, s[40:41]
    ds_read_b128 v[20:23], v3 offset:37888
    s_mov_b64 exec, -1
    v_exp_f32 v63, v63
    v_exp_f32 v64, v64
    v_exp_f32 v65, v65
    v_exp_f32 v66, v66
    v_exp_f32 v67, v67
    s_waitcnt vmcnt(4)
    s_setprio 3
    s_barrier
    v_exp_f32 v36, v36
    v_exp_f32 v37, v37
    v_exp_f32 v38, v38
    v_smfmac_f32_32x32x32_bf16 v[84:99], v[24:27], v[60:67], v5
    s_add_u32 s86, s75, 7
    s_mov_b64 exec, s[40:41]
    ds_read_b128 v[24:27], v3 offset:38144
    s_mov_b64 exec, -1
    v_exp_f32 v39, v39
    v_exp_f32 v40, v40
    v_exp_f32 v41, v41
    v_mfma_f32_32x32x16_bf16 v[52:67], v[12:15], v[32:35], 0
    s_waitcnt lgkmcnt(1)
    s_and_b32 s86, s86, 15
    v_exp_f32 v42, v42
    v_exp_f32 v43, v43
    v_exp_f32 v44, v44
    v_exp_f32 v45, v45
    v_exp_f32 v46, v46
    v_smfmac_f32_32x32x32_bf16 v[68:83], v[20:23], v[36:43], v5
    s_waitcnt lgkmcnt(0)
    s_lshl_b32 s86, s86, 13
    s_add_u32 s86, s86, s62
    s_add_u32 m0, s63, 0
    ds_read_b128 v[12:15], v4 offset:0
    v_exp_f32 v47, v47
    v_exp_f32 v48, v48
    v_exp_f32 v49, v49
    v_exp_f32 v50, v50
    v_exp_f32 v51, v51
    v_exp_f32 v52, v52
    v_exp_f32 v53, v53
    v_exp_f32 v54, v54
    v_smfmac_f32_32x32x32_bf16 v[68:83], v[24:27], v[44:51], v5
    s_setprio 2
    v_exp_f32 v55, v55
    v_exp_f32 v56, v56
    v_exp_f32 v57, v57
    v_mfma_f32_32x32x16_bf16 v[36:51], v[16:19], v[28:31], 0
    buffer_load_dwordx4 v2, s[24:27], s86 offen offset:0 sc1 lds
    v_exp_f32 v58, v58
    v_exp_f32 v59, v59
    v_exp_f32 v60, v60
    v_exp_f32 v61, v61
    v_exp_f32 v62, v62
    v_smfmac_f32_32x32x32_bf16 v[84:99], v[20:23], v[52:59], v5
    s_mov_b64 exec, s[40:41]
    ds_read_b128 v[20:23], v3 offset:39936
    s_mov_b64 exec, -1
    v_exp_f32 v63, v63
    v_exp_f32 v64, v64
    v_exp_f32 v65, v65
    v_exp_f32 v66, v66
    v_exp_f32 v67, v67
    v_exp_f32 v36, v36
    v_exp_f32 v37, v37
    v_exp_f32 v38, v38
    v_smfmac_f32_32x32x32_bf16 v[84:99], v[24:27], v[60:67], v5
    s_mov_b64 exec, s[40:41]
    ds_read_b128 v[24:27], v3 offset:40192
    s_mov_b64 exec, -1
    v_exp_f32 v39, v39
    v_exp_f32 v40, v40
    v_exp_f32 v41, v41
    v_mfma_f32_32x32x16_bf16 v[52:67], v[16:19], v[32:35], 0
    s_waitcnt lgkmcnt(1)
    v_exp_f32 v42, v42
    v_exp_f32 v43, v43
    v_exp_f32 v44, v44
    v_exp_f32 v45, v45
    v_exp_f32 v46, v46
    v_smfmac_f32_32x32x32_bf16 v[68:83], v[20:23], v[36:43], v5
    s_waitcnt lgkmcnt(0)
    ds_read_b128 v[16:19], v4 offset:2048
    v_exp_f32 v47, v47
    v_exp_f32 v48, v48
    v_exp_f32 v49, v49
    v_exp_f32 v50, v50
    v_exp_f32 v51, v51
    v_exp_f32 v52, v52
    v_exp_f32 v53, v53
    v_exp_f32 v54, v54
    v_smfmac_f32_32x32x32_bf16 v[68:83], v[24:27], v[44:51], v5
    s_setprio 1
    v_exp_f32 v55, v55
    v_exp_f32 v56, v56
    v_exp_f32 v57, v57
    v_mfma_f32_32x32x16_bf16 v[36:51], v[12:15], v[28:31], 0
    buffer_load_dwordx4 v2, s[24:27], s86 offen offset:1024 sc1 lds
    v_exp_f32 v58, v58
    v_exp_f32 v59, v59
    v_exp_f32 v60, v60
    v_exp_f32 v61, v61
    v_exp_f32 v62, v62
    v_smfmac_f32_32x32x32_bf16 v[84:99], v[20:23], v[52:59], v5
    s_mov_b64 exec, s[40:41]
    ds_read_b128 v[20:23], v4 offset:1024
    s_mov_b64 exec, -1
    v_exp_f32 v63, v63
    v_exp_f32 v64, v64
    v_exp_f32 v65, v65
    v_exp_f32 v66, v66
    v_exp_f32 v67, v67
    v_exp_f32 v36, v36
    v_exp_f32 v37, v37
    v_exp_f32 v38, v38
    v_smfmac_f32_32x32x32_bf16 v[84:99], v[24:27], v[60:67], v5
    s_mov_b64 exec, s[40:41]
    ds_read_b128 v[24:27], v4 offset:1280
    s_mov_b64 exec, -1
    v_exp_f32 v39, v39
    v_exp_f32 v40, v40
    v_exp_f32 v41, v41
    v_mfma_f32_32x32x16_bf16 v[52:67], v[12:15], v[32:35], 0
    s_waitcnt lgkmcnt(1)
    v_exp_f32 v42, v42
    v_exp_f32 v43, v43
    v_exp_f32 v44, v44
    v_exp_f32 v45, v45
    v_exp_f32 v46, v46
    v_smfmac_f32_32x32x32_bf16 v[68:83], v[20:23], v[36:43], v5
    s_waitcnt lgkmcnt(0)
    ds_read_b128 v[12:15], v4 offset:4096
    v_exp_f32 v47, v47
    v_exp_f32 v48, v48
    v_exp_f32 v49, v49
    v_exp_f32 v50, v50
    v_exp_f32 v51, v51
    v_exp_f32 v52, v52
    v_exp_f32 v53, v53
    v_exp_f32 v54, v54
    v_smfmac_f32_32x32x32_bf16 v[68:83], v[24:27], v[44:51], v5
    s_setprio 0
    v_exp_f32 v55, v55
    v_exp_f32 v56, v56
    v_exp_f32 v57, v57
    v_mfma_f32_32x32x16_bf16 v[36:51], v[16:19], v[28:31], 0
    buffer_load_dwordx4 v2, s[24:27], s86 offen offset:2048 sc1 lds
    v_exp_f32 v58, v58
    v_exp_f32 v59, v59
    v_exp_f32 v60, v60
    v_exp_f32 v61, v61
    v_exp_f32 v62, v62
    v_smfmac_f32_32x32x32_bf16 v[84:99], v[20:23], v[52:59], v5
    s_mov_b64 exec, s[40:41]
    ds_read_b128 v[20:23], v4 offset:3072
    s_mov_b64 exec, -1
    v_exp_f32 v63, v63
    v_exp_f32 v64, v64
    v_exp_f32 v65, v65
    v_exp_f32 v66, v66
    v_exp_f32 v67, v67
    v_exp_f32 v36, v36
    v_exp_f32 v37, v37
    v_exp_f32 v38, v38
    v_smfmac_f32_32x32x32_bf16 v[84:99], v[24:27], v[60:67], v5
    s_mov_b64 exec, s[40:41]
    ds_read_b128 v[24:27], v4 offset:3328
    s_mov_b64 exec, -1
    v_exp_f32 v39, v39
    v_exp_f32 v40, v40
    v_exp_f32 v41, v41
    v_mfma_f32_32x32x16_bf16 v[52:67], v[16:19], v[32:35], 0
    s_waitcnt lgkmcnt(1)
    v_exp_f32 v42, v42
    v_exp_f32 v43, v43
    v_exp_f32 v44, v44
    v_exp_f32 v45, v45
    v_exp_f32 v46, v46
    v_smfmac_f32_32x32x32_bf16 v[68:83], v[20:23], v[36:43], v5
    s_waitcnt lgkmcnt(0)
    ds_read_b128 v[16:19], v4 offset:6144
    v_exp_f32 v47, v47
    v_exp_f32 v48, v48
    v_exp_f32 v49, v49
    v_exp_f32 v50, v50
    v_exp_f32 v51, v51
    v_exp_f32 v52, v52
    v_exp_f32 v53, v53
    v_exp_f32 v54, v54
    v_smfmac_f32_32x32x32_bf16 v[68:83], v[24:27], v[44:51], v5
    v_exp_f32 v55, v55
    v_exp_f32 v56, v56
    v_exp_f32 v57, v57
    v_mfma_f32_32x32x16_bf16 v[36:51], v[12:15], v[28:31], 0
    buffer_load_dwordx4 v2, s[24:27], s86 offen offset:3072 sc1 lds
    v_exp_f32 v58, v58
    v_exp_f32 v59, v59
    v_exp_f32 v60, v60
    v_exp_f32 v61, v61
    v_exp_f32 v62, v62
    v_smfmac_f32_32x32x32_bf16 v[84:99], v[20:23], v[52:59], v5
    s_mov_b64 exec, s[40:41]
    ds_read_b128 v[20:23], v4 offset:5120
    s_mov_b64 exec, -1
    v_exp_f32 v63, v63
    v_exp_f32 v64, v64
    v_exp_f32 v65, v65
    v_exp_f32 v66, v66
    v_exp_f32 v67, v67
    s_waitcnt vmcnt(4)
    s_setprio 3
    s_barrier
    v_exp_f32 v36, v36
    v_exp_f32 v37, v37
    v_exp_f32 v38, v38
    v_smfmac_f32_32x32x32_bf16 v[84:99], v[24:27], v[60:67], v5
    s_add_u32 s86, s75, 8
    s_mov_b64 exec, s[40:41]
    ds_read_b128 v[24:27], v4 offset:5376
    s_mov_b64 exec, -1
    v_exp_f32 v39, v39
    v_exp_f32 v40, v40
    v_exp_f32 v41, v41
    v_mfma_f32_32x32x16_bf16 v[52:67], v[12:15], v[32:35], 0
    s_waitcnt lgkmcnt(1)
    s_and_b32 s86, s86, 15
    v_exp_f32 v42, v42
    v_exp_f32 v43, v43
    v_exp_f32 v44, v44
    v_exp_f32 v45, v45
    v_exp_f32 v46, v46
    v_smfmac_f32_32x32x32_bf16 v[68:83], v[20:23], v[36:43], v5
    s_waitcnt lgkmcnt(0)
    s_lshl_b32 s86, s86, 13
    s_add_u32 s86, s86, s62
    s_add_u32 m0, s63, 32768
    ds_read_b128 v[12:15], v4 offset:32768
    v_exp_f32 v47, v47
    v_exp_f32 v48, v48
    v_exp_f32 v49, v49
    v_exp_f32 v50, v50
    v_exp_f32 v51, v51
    v_exp_f32 v52, v52
    v_exp_f32 v53, v53
    v_exp_f32 v54, v54
    v_smfmac_f32_32x32x32_bf16 v[68:83], v[24:27], v[44:51], v5
    s_setprio 2
    v_exp_f32 v55, v55
    v_exp_f32 v56, v56
    v_exp_f32 v57, v57
    v_mfma_f32_32x32x16_bf16 v[36:51], v[16:19], v[28:31], 0
    buffer_load_dwordx4 v2, s[24:27], s86 offen offset:0 sc1 lds
    v_exp_f32 v58, v58
    v_exp_f32 v59, v59
    v_exp_f32 v60, v60
    v_exp_f32 v61, v61
    v_exp_f32 v62, v62
    v_smfmac_f32_32x32x32_bf16 v[84:99], v[20:23], v[52:59], v5
    s_mov_b64 exec, s[40:41]
    ds_read_b128 v[20:23], v4 offset:7168
    s_mov_b64 exec, -1
    v_exp_f32 v63, v63
    v_exp_f32 v64, v64
    v_exp_f32 v65, v65
    v_exp_f32 v66, v66
    v_exp_f32 v67, v67
    v_exp_f32 v36, v36
    v_exp_f32 v37, v37
    v_exp_f32 v38, v38
    v_smfmac_f32_32x32x32_bf16 v[84:99], v[24:27], v[60:67], v5
    s_mov_b64 exec, s[40:41]
    ds_read_b128 v[24:27], v4 offset:7424
    s_mov_b64 exec, -1
    v_exp_f32 v39, v39
    v_exp_f32 v40, v40
    v_exp_f32 v41, v41
    v_mfma_f32_32x32x16_bf16 v[52:67], v[16:19], v[32:35], 0
    s_waitcnt lgkmcnt(1)
    v_exp_f32 v42, v42
    v_exp_f32 v43, v43
    v_exp_f32 v44, v44
    v_exp_f32 v45, v45
    v_exp_f32 v46, v46
    v_smfmac_f32_32x32x32_bf16 v[68:83], v[20:23], v[36:43], v5
    s_waitcnt lgkmcnt(0)
    ds_read_b128 v[16:19], v4 offset:34816
    v_exp_f32 v47, v47
    v_exp_f32 v48, v48
    v_exp_f32 v49, v49
    v_exp_f32 v50, v50
    v_exp_f32 v51, v51
    v_exp_f32 v52, v52
    v_exp_f32 v53, v53
    v_exp_f32 v54, v54
    v_smfmac_f32_32x32x32_bf16 v[68:83], v[24:27], v[44:51], v5
    s_setprio 1
    v_exp_f32 v55, v55
    v_exp_f32 v56, v56
    v_exp_f32 v57, v57
    v_mfma_f32_32x32x16_bf16 v[36:51], v[12:15], v[28:31], 0
    buffer_load_dwordx4 v2, s[24:27], s86 offen offset:1024 sc1 lds
    v_exp_f32 v58, v58
    v_exp_f32 v59, v59
    v_exp_f32 v60, v60
    v_exp_f32 v61, v61
    v_exp_f32 v62, v62
    v_smfmac_f32_32x32x32_bf16 v[84:99], v[20:23], v[52:59], v5
    s_mov_b64 exec, s[40:41]
    ds_read_b128 v[20:23], v4 offset:33792
    s_mov_b64 exec, -1
    v_exp_f32 v63, v63
    v_exp_f32 v64, v64
    v_exp_f32 v65, v65
    v_exp_f32 v66, v66
    v_exp_f32 v67, v67
    v_exp_f32 v36, v36
    v_exp_f32 v37, v37
    v_exp_f32 v38, v38
    v_smfmac_f32_32x32x32_bf16 v[84:99], v[24:27], v[60:67], v5
    s_mov_b64 exec, s[40:41]
    ds_read_b128 v[24:27], v4 offset:34048
    s_mov_b64 exec, -1
    v_exp_f32 v39, v39
    v_exp_f32 v40, v40
    v_exp_f32 v41, v41
    v_mfma_f32_32x32x16_bf16 v[52:67], v[12:15], v[32:35], 0
    s_waitcnt lgkmcnt(1)
    v_exp_f32 v42, v42
    v_exp_f32 v43, v43
    v_exp_f32 v44, v44
    v_exp_f32 v45, v45
    v_exp_f32 v46, v46
    v_smfmac_f32_32x32x32_bf16 v[68:83], v[20:23], v[36:43], v5
    s_waitcnt lgkmcnt(0)
    ds_read_b128 v[12:15], v4 offset:36864
    v_exp_f32 v47, v47
    v_exp_f32 v48, v48
    v_exp_f32 v49, v49
    v_exp_f32 v50, v50
    v_exp_f32 v51, v51
    v_exp_f32 v52, v52
    v_exp_f32 v53, v53
    v_exp_f32 v54, v54
    v_smfmac_f32_32x32x32_bf16 v[68:83], v[24:27], v[44:51], v5
    s_setprio 0
    v_exp_f32 v55, v55
    v_exp_f32 v56, v56
    v_exp_f32 v57, v57
    v_mfma_f32_32x32x16_bf16 v[36:51], v[16:19], v[28:31], 0
    buffer_load_dwordx4 v2, s[24:27], s86 offen offset:2048 sc1 lds
    v_exp_f32 v58, v58
    v_exp_f32 v59, v59
    v_exp_f32 v60, v60
    v_exp_f32 v61, v61
    v_exp_f32 v62, v62
    v_smfmac_f32_32x32x32_bf16 v[84:99], v[20:23], v[52:59], v5
    s_mov_b64 exec, s[40:41]
    ds_read_b128 v[20:23], v4 offset:35840
    s_mov_b64 exec, -1
    v_exp_f32 v63, v63
    v_exp_f32 v64, v64
    v_exp_f32 v65, v65
    v_exp_f32 v66, v66
    v_exp_f32 v67, v67
    v_exp_f32 v36, v36
    v_exp_f32 v37, v37
    v_exp_f32 v38, v38
    v_smfmac_f32_32x32x32_bf16 v[84:99], v[24:27], v[60:67], v5
    s_mov_b64 exec, s[40:41]
    ds_read_b128 v[24:27], v4 offset:36096
    s_mov_b64 exec, -1
    v_exp_f32 v39, v39
    v_exp_f32 v40, v40
    v_exp_f32 v41, v41
    v_mfma_f32_32x32x16_bf16 v[52:67], v[16:19], v[32:35], 0
    s_waitcnt lgkmcnt(1)
    v_exp_f32 v42, v42
    v_exp_f32 v43, v43
    v_exp_f32 v44, v44
    v_exp_f32 v45, v45
    v_exp_f32 v46, v46
    v_smfmac_f32_32x32x32_bf16 v[68:83], v[20:23], v[36:43], v5
    s_waitcnt lgkmcnt(0)
    ds_read_b128 v[16:19], v4 offset:38912
    v_exp_f32 v47, v47
    v_exp_f32 v48, v48
    v_exp_f32 v49, v49
    v_exp_f32 v50, v50
    v_exp_f32 v51, v51
    v_exp_f32 v52, v52
    v_exp_f32 v53, v53
    v_exp_f32 v54, v54
    v_smfmac_f32_32x32x32_bf16 v[68:83], v[24:27], v[44:51], v5
    v_exp_f32 v55, v55
    v_exp_f32 v56, v56
    v_exp_f32 v57, v57
    v_mfma_f32_32x32x16_bf16 v[36:51], v[12:15], v[28:31], 0
    buffer_load_dwordx4 v2, s[24:27], s86 offen offset:3072 sc1 lds
    v_exp_f32 v58, v58
    v_exp_f32 v59, v59
    v_exp_f32 v60, v60
    v_exp_f32 v61, v61
    v_exp_f32 v62, v62
    v_smfmac_f32_32x32x32_bf16 v[84:99], v[20:23], v[52:59], v5
    s_mov_b64 exec, s[40:41]
    ds_read_b128 v[20:23], v4 offset:37888
    s_mov_b64 exec, -1
    v_exp_f32 v63, v63
    v_exp_f32 v64, v64
    v_exp_f32 v65, v65
    v_exp_f32 v66, v66
    v_exp_f32 v67, v67
    s_waitcnt vmcnt(4)
    s_setprio 3
    s_barrier
    v_exp_f32 v36, v36
    v_exp_f32 v37, v37
    v_exp_f32 v38, v38
    v_smfmac_f32_32x32x32_bf16 v[84:99], v[24:27], v[60:67], v5
    s_add_u32 s86, s75, 9
    s_mov_b64 exec, s[40:41]
    ds_read_b128 v[24:27], v4 offset:38144
    s_mov_b64 exec, -1
    v_exp_f32 v39, v39
    v_exp_f32 v40, v40
    v_exp_f32 v41, v41
    v_mfma_f32_32x32x16_bf16 v[52:67], v[12:15], v[32:35], 0
    s_waitcnt lgkmcnt(1)
    s_and_b32 s86, s86, 15
    v_exp_f32 v42, v42
    v_exp_f32 v43, v43
    v_exp_f32 v44, v44
    v_exp_f32 v45, v45
    v_exp_f32 v46, v46
    v_smfmac_f32_32x32x32_bf16 v[68:83], v[20:23], v[36:43], v5
    s_waitcnt lgkmcnt(0)
    s_lshl_b32 s86, s86, 13
    s_add_u32 s86, s86, s62
    s_add_u32 m0, s63, 65536
    ds_read_b128 v[12:15], v3 offset:0
    v_exp_f32 v47, v47
    v_exp_f32 v48, v48
    v_exp_f32 v49, v49
    v_exp_f32 v50, v50
    v_exp_f32 v51, v51
    v_exp_f32 v52, v52
    v_exp_f32 v53, v53
    v_exp_f32 v54, v54
    v_smfmac_f32_32x32x32_bf16 v[68:83], v[24:27], v[44:51], v5
    s_setprio 2
    v_exp_f32 v55, v55
    v_exp_f32 v56, v56
    v_exp_f32 v57, v57
    v_mfma_f32_32x32x16_bf16 v[36:51], v[16:19], v[28:31], 0
    buffer_load_dwordx4 v2, s[24:27], s86 offen offset:0 sc1 lds
    v_exp_f32 v58, v58
    v_exp_f32 v59, v59
    v_exp_f32 v60, v60
    v_exp_f32 v61, v61
    v_exp_f32 v62, v62
    v_smfmac_f32_32x32x32_bf16 v[84:99], v[20:23], v[52:59], v5
    s_mov_b64 exec, s[40:41]
    ds_read_b128 v[20:23], v4 offset:39936
    s_mov_b64 exec, -1
    v_exp_f32 v63, v63
    v_exp_f32 v64, v64
    v_exp_f32 v65, v65
    v_exp_f32 v66, v66
    v_exp_f32 v67, v67
    v_exp_f32 v36, v36
    v_exp_f32 v37, v37
    v_exp_f32 v38, v38
    v_smfmac_f32_32x32x32_bf16 v[84:99], v[24:27], v[60:67], v5
    s_mov_b64 exec, s[40:41]
    ds_read_b128 v[24:27], v4 offset:40192
    s_mov_b64 exec, -1
    v_exp_f32 v39, v39
    v_exp_f32 v40, v40
    v_exp_f32 v41, v41
    v_mfma_f32_32x32x16_bf16 v[52:67], v[16:19], v[32:35], 0
    s_waitcnt lgkmcnt(1)
    v_exp_f32 v42, v42
    v_exp_f32 v43, v43
    v_exp_f32 v44, v44
    v_exp_f32 v45, v45
    v_exp_f32 v46, v46
    v_smfmac_f32_32x32x32_bf16 v[68:83], v[20:23], v[36:43], v5
    s_waitcnt lgkmcnt(0)
    ds_read_b128 v[16:19], v3 offset:2048
    v_exp_f32 v47, v47
    v_exp_f32 v48, v48
    v_exp_f32 v49, v49
    v_exp_f32 v50, v50
    v_exp_f32 v51, v51
    v_exp_f32 v52, v52
    v_exp_f32 v53, v53
    v_exp_f32 v54, v54
    v_smfmac_f32_32x32x32_bf16 v[68:83], v[24:27], v[44:51], v5
    s_setprio 1
    v_exp_f32 v55, v55
    v_exp_f32 v56, v56
    v_exp_f32 v57, v57
    v_mfma_f32_32x32x16_bf16 v[36:51], v[12:15], v[28:31], 0
    buffer_load_dwordx4 v2, s[24:27], s86 offen offset:1024 sc1 lds
    v_exp_f32 v58, v58
    v_exp_f32 v59, v59
    v_exp_f32 v60, v60
    v_exp_f32 v61, v61
    v_exp_f32 v62, v62
    v_smfmac_f32_32x32x32_bf16 v[84:99], v[20:23], v[52:59], v5
    s_mov_b64 exec, s[40:41]
    ds_read_b128 v[20:23], v3 offset:1024
    s_mov_b64 exec, -1
    v_exp_f32 v63, v63
    v_exp_f32 v64, v64
    v_exp_f32 v65, v65
    v_exp_f32 v66, v66
    v_exp_f32 v67, v67
    v_exp_f32 v36, v36
    v_exp_f32 v37, v37
    v_exp_f32 v38, v38
    v_smfmac_f32_32x32x32_bf16 v[84:99], v[24:27], v[60:67], v5
    s_mov_b64 exec, s[40:41]
    ds_read_b128 v[24:27], v3 offset:1280
    s_mov_b64 exec, -1
    v_exp_f32 v39, v39
    v_exp_f32 v40, v40
    v_exp_f32 v41, v41
    v_mfma_f32_32x32x16_bf16 v[52:67], v[12:15], v[32:35], 0
    s_waitcnt lgkmcnt(1)
    v_exp_f32 v42, v42
    v_exp_f32 v43, v43
    v_exp_f32 v44, v44
    v_exp_f32 v45, v45
    v_exp_f32 v46, v46
    v_smfmac_f32_32x32x32_bf16 v[68:83], v[20:23], v[36:43], v5
    s_waitcnt lgkmcnt(0)
    ds_read_b128 v[12:15], v3 offset:4096
    v_exp_f32 v47, v47
    v_exp_f32 v48, v48
    v_exp_f32 v49, v49
    v_exp_f32 v50, v50
    v_exp_f32 v51, v51
    v_exp_f32 v52, v52
    v_exp_f32 v53, v53
    v_exp_f32 v54, v54
    v_smfmac_f32_32x32x32_bf16 v[68:83], v[24:27], v[44:51], v5
    s_setprio 0
    v_exp_f32 v55, v55
    v_exp_f32 v56, v56
    v_exp_f32 v57, v57
    v_mfma_f32_32x32x16_bf16 v[36:51], v[16:19], v[28:31], 0
    buffer_load_dwordx4 v2, s[24:27], s86 offen offset:2048 sc1 lds
    v_exp_f32 v58, v58
    v_exp_f32 v59, v59
    v_exp_f32 v60, v60
    v_exp_f32 v61, v61
    v_exp_f32 v62, v62
    v_smfmac_f32_32x32x32_bf16 v[84:99], v[20:23], v[52:59], v5
    s_mov_b64 exec, s[40:41]
    ds_read_b128 v[20:23], v3 offset:3072
    s_mov_b64 exec, -1
    v_exp_f32 v63, v63
    v_exp_f32 v64, v64
    v_exp_f32 v65, v65
    v_exp_f32 v66, v66
    v_exp_f32 v67, v67
    v_exp_f32 v36, v36
    v_exp_f32 v37, v37
    v_exp_f32 v38, v38
    v_smfmac_f32_32x32x32_bf16 v[84:99], v[24:27], v[60:67], v5
    s_mov_b64 exec, s[40:41]
    ds_read_b128 v[24:27], v3 offset:3328
    s_mov_b64 exec, -1
    v_exp_f32 v39, v39
    v_exp_f32 v40, v40
    v_exp_f32 v41, v41
    v_mfma_f32_32x32x16_bf16 v[52:67], v[16:19], v[32:35], 0
    s_waitcnt lgkmcnt(1)
    v_exp_f32 v42, v42
    v_exp_f32 v43, v43
    v_exp_f32 v44, v44
    v_exp_f32 v45, v45
    v_exp_f32 v46, v46
    v_smfmac_f32_32x32x32_bf16 v[68:83], v[20:23], v[36:43], v5
    s_waitcnt lgkmcnt(0)
    ds_read_b128 v[16:19], v3 offset:6144
    v_exp_f32 v47, v47
    v_exp_f32 v48, v48
    v_exp_f32 v49, v49
    v_exp_f32 v50, v50
    v_exp_f32 v51, v51
    v_exp_f32 v52, v52
    v_exp_f32 v53, v53
    v_exp_f32 v54, v54
    v_smfmac_f32_32x32x32_bf16 v[68:83], v[24:27], v[44:51], v5
    v_exp_f32 v55, v55
    v_exp_f32 v56, v56
    v_exp_f32 v57, v57
    v_mfma_f32_32x32x16_bf16 v[36:51], v[12:15], v[28:31], 0
    buffer_load_dwordx4 v2, s[24:27], s86 offen offset:3072 sc1 lds
    v_exp_f32 v58, v58
    v_exp_f32 v59, v59
    v_exp_f32 v60, v60
    v_exp_f32 v61, v61
    v_exp_f32 v62, v62
    v_smfmac_f32_32x32x32_bf16 v[84:99], v[20:23], v[52:59], v5
    s_mov_b64 exec, s[40:41]
    ds_read_b128 v[20:23], v3 offset:5120
    s_mov_b64 exec, -1
    v_exp_f32 v63, v63
    v_exp_f32 v64, v64
    v_exp_f32 v65, v65
    v_exp_f32 v66, v66
    v_exp_f32 v67, v67
    s_waitcnt vmcnt(4)
    s_setprio 3
    s_barrier
    v_exp_f32 v36, v36
    v_exp_f32 v37, v37
    v_exp_f32 v38, v38
    v_smfmac_f32_32x32x32_bf16 v[84:99], v[24:27], v[60:67], v5
    s_add_u32 s86, s75, 10
    s_mov_b64 exec, s[40:41]
    ds_read_b128 v[24:27], v3 offset:5376
    s_mov_b64 exec, -1
    v_exp_f32 v39, v39
    v_exp_f32 v40, v40
    v_exp_f32 v41, v41
    v_mfma_f32_32x32x16_bf16 v[52:67], v[12:15], v[32:35], 0
    s_waitcnt lgkmcnt(1)
    s_and_b32 s86, s86, 15
    v_exp_f32 v42, v42
    v_exp_f32 v43, v43
    v_exp_f32 v44, v44
    v_exp_f32 v45, v45
    v_exp_f32 v46, v46
    v_smfmac_f32_32x32x32_bf16 v[68:83], v[20:23], v[36:43], v5
    s_waitcnt lgkmcnt(0)
    s_lshl_b32 s86, s86, 13
    s_add_u32 s86, s86, s62
    s_add_u32 m0, s63, 98304
    ds_read_b128 v[12:15], v3 offset:32768
    v_exp_f32 v47, v47
    v_exp_f32 v48, v48
    v_exp_f32 v49, v49
    v_exp_f32 v50, v50
    v_exp_f32 v51, v51
    v_exp_f32 v52, v52
    v_exp_f32 v53, v53
    v_exp_f32 v54, v54
    v_smfmac_f32_32x32x32_bf16 v[68:83], v[24:27], v[44:51], v5
    s_setprio 2
    v_exp_f32 v55, v55
    v_exp_f32 v56, v56
    v_exp_f32 v57, v57
    v_mfma_f32_32x32x16_bf16 v[36:51], v[16:19], v[28:31], 0
    buffer_load_dwordx4 v2, s[24:27], s86 offen offset:0 sc1 lds
    v_exp_f32 v58, v58
    v_exp_f32 v59, v59
    v_exp_f32 v60, v60
    v_exp_f32 v61, v61
    v_exp_f32 v62, v62
    v_smfmac_f32_32x32x32_bf16 v[84:99], v[20:23], v[52:59], v5
    s_mov_b64 exec, s[40:41]
    ds_read_b128 v[20:23], v3 offset:7168
    s_mov_b64 exec, -1
    v_exp_f32 v63, v63
    v_exp_f32 v64, v64
    v_exp_f32 v65, v65
    v_exp_f32 v66, v66
    v_exp_f32 v67, v67
    v_exp_f32 v36, v36
    v_exp_f32 v37, v37
    v_exp_f32 v38, v38
    v_smfmac_f32_32x32x32_bf16 v[84:99], v[24:27], v[60:67], v5
    s_mov_b64 exec, s[40:41]
    ds_read_b128 v[24:27], v3 offset:7424
    s_mov_b64 exec, -1
    v_exp_f32 v39, v39
    v_exp_f32 v40, v40
    v_exp_f32 v41, v41
    v_mfma_f32_32x32x16_bf16 v[52:67], v[16:19], v[32:35], 0
    s_waitcnt lgkmcnt(1)
    v_exp_f32 v42, v42
    v_exp_f32 v43, v43
    v_exp_f32 v44, v44
    v_exp_f32 v45, v45
    v_exp_f32 v46, v46
    v_smfmac_f32_32x32x32_bf16 v[68:83], v[20:23], v[36:43], v5
    s_waitcnt lgkmcnt(0)
    ds_read_b128 v[16:19], v3 offset:34816
    v_exp_f32 v47, v47
    v_exp_f32 v48, v48
    v_exp_f32 v49, v49
    v_exp_f32 v50, v50
    v_exp_f32 v51, v51
    v_exp_f32 v52, v52
    v_exp_f32 v53, v53
    v_exp_f32 v54, v54
    v_smfmac_f32_32x32x32_bf16 v[68:83], v[24:27], v[44:51], v5
    s_setprio 1
    v_exp_f32 v55, v55
    v_exp_f32 v56, v56
    v_exp_f32 v57, v57
    v_mfma_f32_32x32x16_bf16 v[36:51], v[12:15], v[28:31], 0
    buffer_load_dwordx4 v2, s[24:27], s86 offen offset:1024 sc1 lds
    v_exp_f32 v58, v58
    v_exp_f32 v59, v59
    v_exp_f32 v60, v60
    v_exp_f32 v61, v61
    v_exp_f32 v62, v62
    v_smfmac_f32_32x32x32_bf16 v[84:99], v[20:23], v[52:59], v5
    s_mov_b64 exec, s[40:41]
    ds_read_b128 v[20:23], v3 offset:33792
    s_mov_b64 exec, -1
    v_exp_f32 v63, v63
    v_exp_f32 v64, v64
    v_exp_f32 v65, v65
    v_exp_f32 v66, v66
    v_exp_f32 v67, v67
    v_exp_f32 v36, v36
    v_exp_f32 v37, v37
    v_exp_f32 v38, v38
    v_smfmac_f32_32x32x32_bf16 v[84:99], v[24:27], v[60:67], v5
    s_mov_b64 exec, s[40:41]
    ds_read_b128 v[24:27], v3 offset:34048
    s_mov_b64 exec, -1
    v_exp_f32 v39, v39
    v_exp_f32 v40, v40
    v_exp_f32 v41, v41
    v_mfma_f32_32x32x16_bf16 v[52:67], v[12:15], v[32:35], 0
    s_waitcnt lgkmcnt(1)
    v_exp_f32 v42, v42
    v_exp_f32 v43, v43
    v_exp_f32 v44, v44
    v_exp_f32 v45, v45
    v_exp_f32 v46, v46
    v_smfmac_f32_32x32x32_bf16 v[68:83], v[20:23], v[36:43], v5
    s_waitcnt lgkmcnt(0)
    ds_read_b128 v[12:15], v3 offset:36864
    v_exp_f32 v47, v47
    v_exp_f32 v48, v48
    v_exp_f32 v49, v49
    v_exp_f32 v50, v50
    v_exp_f32 v51, v51
    v_exp_f32 v52, v52
    v_exp_f32 v53, v53
    v_exp_f32 v54, v54
    v_smfmac_f32_32x32x32_bf16 v[68:83], v[24:27], v[44:51], v5
    s_setprio 0
    v_exp_f32 v55, v55
    v_exp_f32 v56, v56
    v_exp_f32 v57, v57
    v_mfma_f32_32x32x16_bf16 v[36:51], v[16:19], v[28:31], 0
    buffer_load_dwordx4 v2, s[24:27], s86 offen offset:2048 sc1 lds
    v_exp_f32 v58, v58
    v_exp_f32 v59, v59
    v_exp_f32 v60, v60
    v_exp_f32 v61, v61
    v_exp_f32 v62, v62
    v_smfmac_f32_32x32x32_bf16 v[84:99], v[20:23], v[52:59], v5
    s_mov_b64 exec, s[40:41]
    ds_read_b128 v[20:23], v3 offset:35840
    s_mov_b64 exec, -1
    v_exp_f32 v63, v63
    v_exp_f32 v64, v64
    v_exp_f32 v65, v65
    v_exp_f32 v66, v66
    v_exp_f32 v67, v67
    v_exp_f32 v36, v36
    v_exp_f32 v37, v37
    v_exp_f32 v38, v38
    v_smfmac_f32_32x32x32_bf16 v[84:99], v[24:27], v[60:67], v5
    s_mov_b64 exec, s[40:41]
    ds_read_b128 v[24:27], v3 offset:36096
    s_mov_b64 exec, -1
    v_exp_f32 v39, v39
    v_exp_f32 v40, v40
    v_exp_f32 v41, v41
    v_mfma_f32_32x32x16_bf16 v[52:67], v[16:19], v[32:35], 0
    s_waitcnt lgkmcnt(1)
    v_exp_f32 v42, v42
    v_exp_f32 v43, v43
    v_exp_f32 v44, v44
    v_exp_f32 v45, v45
    v_exp_f32 v46, v46
    v_smfmac_f32_32x32x32_bf16 v[68:83], v[20:23], v[36:43], v5
    s_waitcnt lgkmcnt(0)
    ds_read_b128 v[16:19], v3 offset:38912
    v_exp_f32 v47, v47
    v_exp_f32 v48, v48
    v_exp_f32 v49, v49
    v_exp_f32 v50, v50
    v_exp_f32 v51, v51
    v_exp_f32 v52, v52
    v_exp_f32 v53, v53
    v_exp_f32 v54, v54
    v_smfmac_f32_32x32x32_bf16 v[68:83], v[24:27], v[44:51], v5
    v_exp_f32 v55, v55
    v_exp_f32 v56, v56
    v_exp_f32 v57, v57
    v_mfma_f32_32x32x16_bf16 v[36:51], v[12:15], v[28:31], 0
    buffer_load_dwordx4 v2, s[24:27], s86 offen offset:3072 sc1 lds
    v_exp_f32 v58, v58
    v_exp_f32 v59, v59
    v_exp_f32 v60, v60
    v_exp_f32 v61, v61
    v_exp_f32 v62, v62
    v_smfmac_f32_32x32x32_bf16 v[84:99], v[20:23], v[52:59], v5
    s_mov_b64 exec, s[40:41]
    ds_read_b128 v[20:23], v3 offset:37888
    s_mov_b64 exec, -1
    v_exp_f32 v63, v63
    v_exp_f32 v64, v64
    v_exp_f32 v65, v65
    v_exp_f32 v66, v66
    v_exp_f32 v67, v67
    s_waitcnt vmcnt(4)
    s_setprio 3
    s_barrier
    v_exp_f32 v36, v36
    v_exp_f32 v37, v37
    v_exp_f32 v38, v38
    v_smfmac_f32_32x32x32_bf16 v[84:99], v[24:27], v[60:67], v5
    s_add_u32 s86, s75, 11
    s_mov_b64 exec, s[40:41]
    ds_read_b128 v[24:27], v3 offset:38144
    s_mov_b64 exec, -1
    v_exp_f32 v39, v39
    v_exp_f32 v40, v40
    v_exp_f32 v41, v41
    v_mfma_f32_32x32x16_bf16 v[52:67], v[12:15], v[32:35], 0
    s_waitcnt lgkmcnt(1)
    s_and_b32 s86, s86, 15
    v_exp_f32 v42, v42
    v_exp_f32 v43, v43
    v_exp_f32 v44, v44
    v_exp_f32 v45, v45
    v_exp_f32 v46, v46
    v_smfmac_f32_32x32x32_bf16 v[68:83], v[20:23], v[36:43], v5
    s_waitcnt lgkmcnt(0)
    s_lshl_b32 s86, s86, 13
    s_add_u32 s86, s86, s62
    s_add_u32 m0, s63, 0
    ds_read_b128 v[12:15], v4 offset:0
    v_exp_f32 v47, v47
    v_exp_f32 v48, v48
    v_exp_f32 v49, v49
    v_exp_f32 v50, v50
    v_exp_f32 v51, v51
    v_exp_f32 v52, v52
    v_exp_f32 v53, v53
    v_exp_f32 v54, v54
    v_smfmac_f32_32x32x32_bf16 v[68:83], v[24:27], v[44:51], v5
    s_setprio 2
    v_exp_f32 v55, v55
    v_exp_f32 v56, v56
    v_exp_f32 v57, v57
    v_mfma_f32_32x32x16_bf16 v[36:51], v[16:19], v[28:31], 0
    buffer_load_dwordx4 v2, s[24:27], s86 offen offset:0 sc1 lds
    v_exp_f32 v58, v58
    v_exp_f32 v59, v59
    v_exp_f32 v60, v60
    v_exp_f32 v61, v61
    v_exp_f32 v62, v62
    v_smfmac_f32_32x32x32_bf16 v[84:99], v[20:23], v[52:59], v5
    s_mov_b64 exec, s[40:41]
    ds_read_b128 v[20:23], v3 offset:39936
    s_mov_b64 exec, -1
    v_exp_f32 v63, v63
    v_exp_f32 v64, v64
    v_exp_f32 v65, v65
    v_exp_f32 v66, v66
    v_exp_f32 v67, v67
    v_exp_f32 v36, v36
    v_exp_f32 v37, v37
    v_exp_f32 v38, v38
    v_smfmac_f32_32x32x32_bf16 v[84:99], v[24:27], v[60:67], v5
    s_mov_b64 exec, s[40:41]
    ds_read_b128 v[24:27], v3 offset:40192
    s_mov_b64 exec, -1
    v_exp_f32 v39, v39
    v_exp_f32 v40, v40
    v_exp_f32 v41, v41
    v_mfma_f32_32x32x16_bf16 v[52:67], v[16:19], v[32:35], 0
    s_waitcnt lgkmcnt(1)
    v_exp_f32 v42, v42
    v_exp_f32 v43, v43
    v_exp_f32 v44, v44
    v_exp_f32 v45, v45
    v_exp_f32 v46, v46
    v_smfmac_f32_32x32x32_bf16 v[68:83], v[20:23], v[36:43], v5
    s_waitcnt lgkmcnt(0)
    ds_read_b128 v[16:19], v4 offset:2048
    v_exp_f32 v47, v47
    v_exp_f32 v48, v48
    v_exp_f32 v49, v49
    v_exp_f32 v50, v50
    v_exp_f32 v51, v51
    v_exp_f32 v52, v52
    v_exp_f32 v53, v53
    v_exp_f32 v54, v54
    v_smfmac_f32_32x32x32_bf16 v[68:83], v[24:27], v[44:51], v5
    s_setprio 1
    v_exp_f32 v55, v55
    v_exp_f32 v56, v56
    v_exp_f32 v57, v57
    v_mfma_f32_32x32x16_bf16 v[36:51], v[12:15], v[28:31], 0
    buffer_load_dwordx4 v2, s[24:27], s86 offen offset:1024 sc1 lds
    v_exp_f32 v58, v58
    v_exp_f32 v59, v59
    v_exp_f32 v60, v60
    v_exp_f32 v61, v61
    v_exp_f32 v62, v62
    v_smfmac_f32_32x32x32_bf16 v[84:99], v[20:23], v[52:59], v5
    s_mov_b64 exec, s[40:41]
    ds_read_b128 v[20:23], v4 offset:1024
    s_mov_b64 exec, -1
    v_exp_f32 v63, v63
    v_exp_f32 v64, v64
    v_exp_f32 v65, v65
    v_exp_f32 v66, v66
    v_exp_f32 v67, v67
    v_exp_f32 v36, v36
    v_exp_f32 v37, v37
    v_exp_f32 v38, v38
    v_smfmac_f32_32x32x32_bf16 v[84:99], v[24:27], v[60:67], v5
    s_mov_b64 exec, s[40:41]
    ds_read_b128 v[24:27], v4 offset:1280
    s_mov_b64 exec, -1
    v_exp_f32 v39, v39
    v_exp_f32 v40, v40
    v_exp_f32 v41, v41
    v_mfma_f32_32x32x16_bf16 v[52:67], v[12:15], v[32:35], 0
    s_waitcnt lgkmcnt(1)
    v_exp_f32 v42, v42
    v_exp_f32 v43, v43
    v_exp_f32 v44, v44
    v_exp_f32 v45, v45
    v_exp_f32 v46, v46
    v_smfmac_f32_32x32x32_bf16 v[68:83], v[20:23], v[36:43], v5
    s_waitcnt lgkmcnt(0)
    ds_read_b128 v[12:15], v4 offset:4096
    v_exp_f32 v47, v47
    v_exp_f32 v48, v48
    v_exp_f32 v49, v49
    v_exp_f32 v50, v50
    v_exp_f32 v51, v51
    v_exp_f32 v52, v52
    v_exp_f32 v53, v53
    v_exp_f32 v54, v54
    v_smfmac_f32_32x32x32_bf16 v[68:83], v[24:27], v[44:51], v5
    s_setprio 0
    buffer_load_dwordx4 v2, s[24:27], s86 offen offset:2048 sc1 lds
    v_exp_f32 v55, v55
    v_exp_f32 v56, v56
    v_exp_f32 v57, v57
    v_mfma_f32_32x32x16_bf16 v[36:51], v[16:19], v[28:31], 0
    v_and_b32 v244, 7, v1
    v_lshlrev_b32 v244, 11, v244
    buffer_load_dwordx2 v[232:233], v244, s[24:27], s74 offen sc1
    v_exp_f32 v58, v58
    v_exp_f32 v59, v59
    v_exp_f32 v60, v60
    v_exp_f32 v61, v61
    v_exp_f32 v62, v62
    v_smfmac_f32_32x32x32_bf16 v[84:99], v[20:23], v[52:59], v5
    s_mov_b64 exec, s[40:41]
    ds_read_b128 v[20:23], v4 offset:3072
    s_mov_b64 exec, -1
    v_exp_f32 v63, v63
    v_exp_f32 v64, v64
    v_exp_f32 v65, v65
    v_exp_f32 v66, v66
    v_exp_f32 v67, v67
    v_exp_f32 v36, v36
    v_exp_f32 v37, v37
    v_exp_f32 v38, v38
    v_smfmac_f32_32x32x32_bf16 v[84:99], v[24:27], v[60:67], v5
    s_mov_b64 exec, s[40:41]
    ds_read_b128 v[24:27], v4 offset:3328
    s_mov_b64 exec, -1
    v_exp_f32 v39, v39
    v_exp_f32 v40, v40
    v_exp_f32 v41, v41
    v_mfma_f32_32x32x16_bf16 v[52:67], v[16:19], v[32:35], 0
    s_waitcnt lgkmcnt(1)
    v_exp_f32 v42, v42
    v_exp_f32 v43, v43
    v_exp_f32 v44, v44
    v_exp_f32 v45, v45
    v_exp_f32 v46, v46
    v_smfmac_f32_32x32x32_bf16 v[68:83], v[20:23], v[36:43], v5
    s_waitcnt lgkmcnt(0)
    ds_read_b128 v[16:19], v4 offset:6144
    v_exp_f32 v47, v47
    v_exp_f32 v48, v48
    v_exp_f32 v49, v49
    v_exp_f32 v50, v50
    v_exp_f32 v51, v51
    v_exp_f32 v52, v52
    v_exp_f32 v53, v53
    v_exp_f32 v54, v54
    v_smfmac_f32_32x32x32_bf16 v[68:83], v[24:27], v[44:51], v5
    v_exp_f32 v55, v55
    v_exp_f32 v56, v56
    v_exp_f32 v57, v57
    v_mfma_f32_32x32x16_bf16 v[36:51], v[12:15], v[28:31], 0
    buffer_load_dwordx4 v2, s[24:27], s86 offen offset:3072 sc1 lds
    v_exp_f32 v58, v58
    v_exp_f32 v59, v59
    v_exp_f32 v60, v60
    v_exp_f32 v61, v61
    v_exp_f32 v62, v62
    v_smfmac_f32_32x32x32_bf16 v[84:99], v[20:23], v[52:59], v5
    s_mov_b64 exec, s[40:41]
    ds_read_b128 v[20:23], v4 offset:5120
    s_mov_b64 exec, -1
    v_exp_f32 v63, v63
    v_exp_f32 v64, v64
    v_exp_f32 v65, v65
    v_exp_f32 v66, v66
    v_exp_f32 v67, v67
    s_waitcnt vmcnt(5)
    s_setprio 3
    s_barrier
    v_exp_f32 v36, v36
    v_exp_f32 v37, v37
    v_exp_f32 v38, v38
    v_smfmac_f32_32x32x32_bf16 v[84:99], v[24:27], v[60:67], v5
    s_add_u32 s86, s75, 12
    s_mov_b64 exec, s[40:41]
    ds_read_b128 v[24:27], v4 offset:5376
    s_mov_b64 exec, -1
    v_exp_f32 v39, v39
    v_exp_f32 v40, v40
    v_exp_f32 v41, v41
    v_mfma_f32_32x32x16_bf16 v[52:67], v[12:15], v[32:35], 0
    s_waitcnt lgkmcnt(1)
    s_and_b32 s86, s86, 15
    v_exp_f32 v42, v42
    v_exp_f32 v43, v43
    v_exp_f32 v44, v44
    v_exp_f32 v45, v45
    v_exp_f32 v46, v46
    v_smfmac_f32_32x32x32_bf16 v[68:83], v[20:23], v[36:43], v5
    s_waitcnt lgkmcnt(0)
    s_lshl_b32 s86, s86, 13
    s_add_u32 s86, s86, s62
    s_add_u32 m0, s63, 32768
    ds_read_b128 v[12:15], v4 offset:32768
    v_exp_f32 v47, v47
    v_exp_f32 v48, v48
    v_exp_f32 v49, v49
    v_exp_f32 v50, v50
    v_exp_f32 v51, v51
    v_exp_f32 v52, v52
    v_exp_f32 v53, v53
    v_exp_f32 v54, v54
    v_smfmac_f32_32x32x32_bf16 v[68:83], v[24:27], v[44:51], v5
    s_setprio 2
    v_exp_f32 v55, v55
    v_exp_f32 v56, v56
    v_exp_f32 v57, v57
    v_mfma_f32_32x32x16_bf16 v[36:51], v[16:19], v[28:31], 0
    buffer_load_dwordx4 v2, s[24:27], s86 offen offset:0 sc1 lds
    v_exp_f32 v58, v58
    v_exp_f32 v59, v59
    v_exp_f32 v60, v60
    v_exp_f32 v61, v61
    v_exp_f32 v62, v62
    v_smfmac_f32_32x32x32_bf16 v[84:99], v[20:23], v[52:59], v5
    s_mov_b64 exec, s[40:41]
    ds_read_b128 v[20:23], v4 offset:7168
    s_mov_b64 exec, -1
    v_exp_f32 v63, v63
    v_exp_f32 v64, v64
    v_exp_f32 v65, v65
    v_exp_f32 v66, v66
    v_exp_f32 v67, v67
    v_exp_f32 v36, v36
    v_exp_f32 v37, v37
    v_exp_f32 v38, v38
    v_smfmac_f32_32x32x32_bf16 v[84:99], v[24:27], v[60:67], v5
    s_mov_b64 exec, s[40:41]
    ds_read_b128 v[24:27], v4 offset:7424
    s_mov_b64 exec, -1
    v_exp_f32 v39, v39
    v_exp_f32 v40, v40
    v_exp_f32 v41, v41
    v_mfma_f32_32x32x16_bf16 v[52:67], v[16:19], v[32:35], 0
    s_waitcnt lgkmcnt(1)
    v_exp_f32 v42, v42
    v_exp_f32 v43, v43
    v_exp_f32 v44, v44
    v_exp_f32 v45, v45
    v_exp_f32 v46, v46
    v_smfmac_f32_32x32x32_bf16 v[68:83], v[20:23], v[36:43], v5
    s_waitcnt lgkmcnt(0)
    ds_read_b128 v[16:19], v4 offset:34816
    v_exp_f32 v47, v47
    v_exp_f32 v48, v48
    v_exp_f32 v49, v49
    v_exp_f32 v50, v50
    v_exp_f32 v51, v51
    v_exp_f32 v52, v52
    v_exp_f32 v53, v53
    v_exp_f32 v54, v54
    v_smfmac_f32_32x32x32_bf16 v[68:83], v[24:27], v[44:51], v5
    s_setprio 1
    v_exp_f32 v55, v55
    v_exp_f32 v56, v56
    v_exp_f32 v57, v57
    v_mfma_f32_32x32x16_bf16 v[36:51], v[12:15], v[28:31], 0
    buffer_load_dwordx4 v2, s[24:27], s86 offen offset:1024 sc1 lds
    v_exp_f32 v58, v58
    v_exp_f32 v59, v59
    v_exp_f32 v60, v60
    v_exp_f32 v61, v61
    v_exp_f32 v62, v62
    v_smfmac_f32_32x32x32_bf16 v[84:99], v[20:23], v[52:59], v5
    s_mov_b64 exec, s[40:41]
    ds_read_b128 v[20:23], v4 offset:33792
    s_mov_b64 exec, -1
    v_exp_f32 v63, v63
    v_exp_f32 v64, v64
    v_exp_f32 v65, v65
    v_exp_f32 v66, v66
    v_exp_f32 v67, v67
    v_exp_f32 v36, v36
    v_exp_f32 v37, v37
    v_exp_f32 v38, v38
    v_smfmac_f32_32x32x32_bf16 v[84:99], v[24:27], v[60:67], v5
    s_mov_b64 exec, s[40:41]
    ds_read_b128 v[24:27], v4 offset:34048
    s_mov_b64 exec, -1
    v_exp_f32 v39, v39
    v_exp_f32 v40, v40
    v_exp_f32 v41, v41
    v_mfma_f32_32x32x16_bf16 v[52:67], v[12:15], v[32:35], 0
    s_waitcnt lgkmcnt(1)
    v_exp_f32 v42, v42
    v_exp_f32 v43, v43
    v_exp_f32 v44, v44
    v_exp_f32 v45, v45
    v_exp_f32 v46, v46
    v_smfmac_f32_32x32x32_bf16 v[68:83], v[20:23], v[36:43], v5
    s_waitcnt lgkmcnt(0)
    ds_read_b128 v[12:15], v4 offset:36864
    v_exp_f32 v47, v47
    v_exp_f32 v48, v48
    v_exp_f32 v49, v49
    v_exp_f32 v50, v50
    v_exp_f32 v51, v51
    v_exp_f32 v52, v52
    v_exp_f32 v53, v53
    v_exp_f32 v54, v54
    v_smfmac_f32_32x32x32_bf16 v[68:83], v[24:27], v[44:51], v5
    s_setprio 0
    v_exp_f32 v55, v55
    v_exp_f32 v56, v56
    v_exp_f32 v57, v57
    v_mfma_f32_32x32x16_bf16 v[36:51], v[16:19], v[28:31], 0
    buffer_load_dwordx4 v2, s[24:27], s86 offen offset:2048 sc1 lds
    v_exp_f32 v58, v58
    v_exp_f32 v59, v59
    v_exp_f32 v60, v60
    v_exp_f32 v61, v61
    v_exp_f32 v62, v62
    v_smfmac_f32_32x32x32_bf16 v[84:99], v[20:23], v[52:59], v5
    s_mov_b64 exec, s[40:41]
    ds_read_b128 v[20:23], v4 offset:35840
    s_mov_b64 exec, -1
    v_exp_f32 v63, v63
    v_exp_f32 v64, v64
    v_exp_f32 v65, v65
    v_exp_f32 v66, v66
    v_exp_f32 v67, v67
    v_exp_f32 v36, v36
    v_exp_f32 v37, v37
    v_exp_f32 v38, v38
    v_smfmac_f32_32x32x32_bf16 v[84:99], v[24:27], v[60:67], v5
    s_mov_b64 exec, s[40:41]
    ds_read_b128 v[24:27], v4 offset:36096
    s_mov_b64 exec, -1
    v_exp_f32 v39, v39
    v_exp_f32 v40, v40
    v_exp_f32 v41, v41
    v_mfma_f32_32x32x16_bf16 v[52:67], v[16:19], v[32:35], 0
    s_waitcnt lgkmcnt(1)
    v_exp_f32 v42, v42
    v_exp_f32 v43, v43
    v_exp_f32 v44, v44
    v_exp_f32 v45, v45
    v_exp_f32 v46, v46
    v_smfmac_f32_32x32x32_bf16 v[68:83], v[20:23], v[36:43], v5
    s_waitcnt lgkmcnt(0)
    ds_read_b128 v[16:19], v4 offset:38912
    v_exp_f32 v47, v47
    v_exp_f32 v48, v48
    v_exp_f32 v49, v49
    v_exp_f32 v50, v50
    v_exp_f32 v51, v51
    v_exp_f32 v52, v52
    v_exp_f32 v53, v53
    v_exp_f32 v54, v54
    v_smfmac_f32_32x32x32_bf16 v[68:83], v[24:27], v[44:51], v5
    v_exp_f32 v55, v55
    v_exp_f32 v56, v56
    v_exp_f32 v57, v57
    v_mfma_f32_32x32x16_bf16 v[36:51], v[12:15], v[28:31], 0
    buffer_load_dwordx4 v2, s[24:27], s86 offen offset:3072 sc1 lds
    v_exp_f32 v58, v58
    v_exp_f32 v59, v59
    v_exp_f32 v60, v60
    v_exp_f32 v61, v61
    v_exp_f32 v62, v62
    v_smfmac_f32_32x32x32_bf16 v[84:99], v[20:23], v[52:59], v5
    s_mov_b64 exec, s[40:41]
    ds_read_b128 v[20:23], v4 offset:37888
    s_mov_b64 exec, -1
    v_exp_f32 v63, v63
    v_exp_f32 v64, v64
    v_exp_f32 v65, v65
    v_exp_f32 v66, v66
    v_exp_f32 v67, v67
    s_waitcnt vmcnt(4)
    s_setprio 3
    s_barrier
    v_exp_f32 v36, v36
    v_exp_f32 v37, v37
    v_exp_f32 v38, v38
    v_smfmac_f32_32x32x32_bf16 v[84:99], v[24:27], v[60:67], v5
    s_add_u32 s86, s75, 13
    s_mov_b64 exec, s[40:41]
    ds_read_b128 v[24:27], v4 offset:38144
    s_mov_b64 exec, -1
    v_exp_f32 v39, v39
    v_exp_f32 v40, v40
    v_exp_f32 v41, v41
    v_mfma_f32_32x32x16_bf16 v[52:67], v[12:15], v[32:35], 0
    s_waitcnt lgkmcnt(1)
    s_and_b32 s86, s86, 15
    v_exp_f32 v42, v42
    v_exp_f32 v43, v43
    v_exp_f32 v44, v44
    v_exp_f32 v45, v45
    v_exp_f32 v46, v46
    v_smfmac_f32_32x32x32_bf16 v[68:83], v[20:23], v[36:43], v5
    s_waitcnt lgkmcnt(0)
    s_lshl_b32 s86, s86, 13
    s_add_u32 s86, s86, s62
    s_add_u32 m0, s63, 65536
    ds_read_b128 v[12:15], v3 offset:0
    v_exp_f32 v47, v47
    v_exp_f32 v48, v48
    v_exp_f32 v49, v49
    v_exp_f32 v50, v50
    v_exp_f32 v51, v51
    v_exp_f32 v52, v52
    v_exp_f32 v53, v53
    v_exp_f32 v54, v54
    v_smfmac_f32_32x32x32_bf16 v[68:83], v[24:27], v[44:51], v5
    s_setprio 2
    v_exp_f32 v55, v55
    v_exp_f32 v56, v56
    v_exp_f32 v57, v57
    v_mfma_f32_32x32x16_bf16 v[36:51], v[16:19], v[28:31], 0
    buffer_load_dwordx4 v2, s[24:27], s86 offen offset:0 sc1 lds
    v_exp_f32 v58, v58
    v_exp_f32 v59, v59
    v_exp_f32 v60, v60
    v_exp_f32 v61, v61
    v_exp_f32 v62, v62
    v_smfmac_f32_32x32x32_bf16 v[84:99], v[20:23], v[52:59], v5
    s_mov_b64 exec, s[40:41]
    ds_read_b128 v[20:23], v4 offset:39936
    s_mov_b64 exec, -1
    v_exp_f32 v63, v63
    v_exp_f32 v64, v64
    v_exp_f32 v65, v65
    v_exp_f32 v66, v66
    v_exp_f32 v67, v67
    v_exp_f32 v36, v36
    v_exp_f32 v37, v37
    v_exp_f32 v38, v38
    v_smfmac_f32_32x32x32_bf16 v[84:99], v[24:27], v[60:67], v5
    s_mov_b64 exec, s[40:41]
    ds_read_b128 v[24:27], v4 offset:40192
    s_mov_b64 exec, -1
    v_exp_f32 v39, v39
    v_exp_f32 v40, v40
    v_exp_f32 v41, v41
    v_mfma_f32_32x32x16_bf16 v[52:67], v[16:19], v[32:35], 0
    s_waitcnt lgkmcnt(1)
    v_exp_f32 v42, v42
    v_exp_f32 v43, v43
    v_exp_f32 v44, v44
    v_exp_f32 v45, v45
    v_exp_f32 v46, v46
    v_smfmac_f32_32x32x32_bf16 v[68:83], v[20:23], v[36:43], v5
    s_waitcnt lgkmcnt(0)
    ds_read_b128 v[16:19], v3 offset:2048
    v_exp_f32 v47, v47
    v_exp_f32 v48, v48
    v_exp_f32 v49, v49
    v_exp_f32 v50, v50
    v_exp_f32 v51, v51
    v_exp_f32 v52, v52
    v_exp_f32 v53, v53
    v_exp_f32 v54, v54
    v_smfmac_f32_32x32x32_bf16 v[68:83], v[24:27], v[44:51], v5
    s_setprio 1
    v_exp_f32 v55, v55
    v_exp_f32 v56, v56
    v_exp_f32 v57, v57
    v_mfma_f32_32x32x16_bf16 v[36:51], v[12:15], v[28:31], 0
    buffer_load_dwordx4 v2, s[24:27], s86 offen offset:1024 sc1 lds
    v_exp_f32 v58, v58
    v_exp_f32 v59, v59
    v_exp_f32 v60, v60
    v_exp_f32 v61, v61
    v_exp_f32 v62, v62
    v_smfmac_f32_32x32x32_bf16 v[84:99], v[20:23], v[52:59], v5
    s_mov_b64 exec, s[40:41]
    ds_read_b128 v[20:23], v3 offset:1024
    s_mov_b64 exec, -1
    v_exp_f32 v63, v63
    v_exp_f32 v64, v64
    v_exp_f32 v65, v65
    v_exp_f32 v66, v66
    v_exp_f32 v67, v67
    v_exp_f32 v36, v36
    v_exp_f32 v37, v37
    v_exp_f32 v38, v38
    v_smfmac_f32_32x32x32_bf16 v[84:99], v[24:27], v[60:67], v5
    s_mov_b64 exec, s[40:41]
    ds_read_b128 v[24:27], v3 offset:1280
    s_mov_b64 exec, -1
    v_exp_f32 v39, v39
    v_exp_f32 v40, v40
    v_exp_f32 v41, v41
    v_mfma_f32_32x32x16_bf16 v[52:67], v[12:15], v[32:35], 0
    s_waitcnt lgkmcnt(1)
    v_exp_f32 v42, v42
    v_exp_f32 v43, v43
    v_exp_f32 v44, v44
    v_exp_f32 v45, v45
    v_exp_f32 v46, v46
    v_smfmac_f32_32x32x32_bf16 v[68:83], v[20:23], v[36:43], v5
    s_waitcnt lgkmcnt(0)
    ds_read_b128 v[12:15], v3 offset:4096
    v_exp_f32 v47, v47
    v_exp_f32 v48, v48
    v_exp_f32 v49, v49
    v_exp_f32 v50, v50
    v_exp_f32 v51, v51
    v_exp_f32 v52, v52
    v_exp_f32 v53, v53
    v_exp_f32 v54, v54
    v_smfmac_f32_32x32x32_bf16 v[68:83], v[24:27], v[44:51], v5
    s_setprio 0
    v_exp_f32 v55, v55
    v_exp_f32 v56, v56
    v_exp_f32 v57, v57
    v_mfma_f32_32x32x16_bf16 v[36:51], v[16:19], v[28:31], 0
    buffer_load_dwordx4 v2, s[24:27], s86 offen offset:2048 sc1 lds
    v_exp_f32 v58, v58
    v_exp_f32 v59, v59
    v_exp_f32 v60, v60
    v_exp_f32 v61, v61
    v_exp_f32 v62, v62
    v_smfmac_f32_32x32x32_bf16 v[84:99], v[20:23], v[52:59], v5
    s_mov_b64 exec, s[40:41]
    ds_read_b128 v[20:23], v3 offset:3072
    s_mov_b64 exec, -1
    v_exp_f32 v63, v63
    v_exp_f32 v64, v64
    v_exp_f32 v65, v65
    v_exp_f32 v66, v66
    v_exp_f32 v67, v67
    v_exp_f32 v36, v36
    v_exp_f32 v37, v37
    v_exp_f32 v38, v38
    v_smfmac_f32_32x32x32_bf16 v[84:99], v[24:27], v[60:67], v5
    s_mov_b64 exec, s[40:41]
    ds_read_b128 v[24:27], v3 offset:3328
    s_mov_b64 exec, -1
    v_exp_f32 v39, v39
    v_exp_f32 v40, v40
    v_exp_f32 v41, v41
    v_mfma_f32_32x32x16_bf16 v[52:67], v[16:19], v[32:35], 0
    s_waitcnt lgkmcnt(1)
    v_exp_f32 v42, v42
    v_exp_f32 v43, v43
    v_exp_f32 v44, v44
    v_exp_f32 v45, v45
    v_exp_f32 v46, v46
    v_smfmac_f32_32x32x32_bf16 v[68:83], v[20:23], v[36:43], v5
    s_waitcnt lgkmcnt(0)
    ds_read_b128 v[16:19], v3 offset:6144
    v_exp_f32 v47, v47
    v_exp_f32 v48, v48
    v_exp_f32 v49, v49
    v_exp_f32 v50, v50
    v_exp_f32 v51, v51
    v_exp_f32 v52, v52
    v_exp_f32 v53, v53
    v_exp_f32 v54, v54
    v_smfmac_f32_32x32x32_bf16 v[68:83], v[24:27], v[44:51], v5
    v_exp_f32 v55, v55
    v_exp_f32 v56, v56
    v_exp_f32 v57, v57
    v_mfma_f32_32x32x16_bf16 v[36:51], v[12:15], v[28:31], 0
    buffer_load_dwordx4 v2, s[24:27], s86 offen offset:3072 sc1 lds
    v_exp_f32 v58, v58
    v_exp_f32 v59, v59
    v_exp_f32 v60, v60
    v_exp_f32 v61, v61
    v_exp_f32 v62, v62
    v_smfmac_f32_32x32x32_bf16 v[84:99], v[20:23], v[52:59], v5
    s_mov_b64 exec, s[40:41]
    ds_read_b128 v[20:23], v3 offset:5120
    s_mov_b64 exec, -1
    v_exp_f32 v63, v63
    v_exp_f32 v64, v64
    v_exp_f32 v65, v65
    v_exp_f32 v66, v66
    v_exp_f32 v67, v67
    s_waitcnt vmcnt(4)
    s_setprio 3
    s_barrier
    v_exp_f32 v36, v36
    v_exp_f32 v37, v37
    v_exp_f32 v38, v38
    v_smfmac_f32_32x32x32_bf16 v[84:99], v[24:27], v[60:67], v5
    s_add_u32 s86, s75, 14
    s_mov_b64 exec, s[40:41]
    ds_read_b128 v[24:27], v3 offset:5376
    s_mov_b64 exec, -1
    v_exp_f32 v39, v39
    v_exp_f32 v40, v40
    v_exp_f32 v41, v41
    v_mfma_f32_32x32x16_bf16 v[52:67], v[12:15], v[32:35], 0
    s_waitcnt lgkmcnt(1)
    s_and_b32 s86, s86, 15
    v_exp_f32 v42, v42
    v_exp_f32 v43, v43
    v_exp_f32 v44, v44
    v_exp_f32 v45, v45
    v_exp_f32 v46, v46
    v_smfmac_f32_32x32x32_bf16 v[68:83], v[20:23], v[36:43], v5
    s_waitcnt lgkmcnt(0)
    s_lshl_b32 s86, s86, 13
    s_add_u32 s86, s86, s62
    s_add_u32 m0, s63, 98304
    ds_read_b128 v[12:15], v3 offset:32768
    v_exp_f32 v47, v47
    v_exp_f32 v48, v48
    v_exp_f32 v49, v49
    v_exp_f32 v50, v50
    v_exp_f32 v51, v51
    v_exp_f32 v52, v52
    v_exp_f32 v53, v53
    v_exp_f32 v54, v54
    v_smfmac_f32_32x32x32_bf16 v[68:83], v[24:27], v[44:51], v5
    s_setprio 2
    buffer_load_dwordx4 v2, s[24:27], s86 offen offset:0 sc1 lds
    v_exp_f32 v55, v55
    v_exp_f32 v56, v56
    v_exp_f32 v57, v57
    v_mfma_f32_32x32x16_bf16 v[36:51], v[16:19], v[28:31], 0
    v_cmp_ne_u64 s[66:67], v[242:243], v[232:233]
    v_and_b32 v244, 7, v1
    v_lshlrev_b32 v244, 7, v244
    v_bfe_u32 v245, v1, 3, 1
    v_lshl_add_u32 v244, v245, 15, v244
    v_add_u32 v244, s81, v244
    v_writelane_b32 v244, s82, 16
    s_mov_b64 exec, 0x1ffff
    buffer_load_dword v245, v244, s[24:27], 0 offen
    s_mov_b64 exec, -1
    v_exp_f32 v58, v58
    v_exp_f32 v59, v59
    v_exp_f32 v60, v60
    v_exp_f32 v61, v61
    v_exp_f32 v62, v62
    v_smfmac_f32_32x32x32_bf16 v[84:99], v[20:23], v[52:59], v5
    s_mov_b64 exec, s[40:41]
    ds_read_b128 v[20:23], v3 offset:7168
    s_mov_b64 exec, -1
    v_exp_f32 v63, v63
    v_exp_f32 v64, v64
    v_exp_f32 v65, v65
    v_exp_f32 v66, v66
    v_exp_f32 v67, v67
    v_exp_f32 v36, v36
    v_exp_f32 v37, v37
    v_exp_f32 v38, v38
    v_smfmac_f32_32x32x32_bf16 v[84:99], v[24:27], v[60:67], v5
    s_mov_b64 exec, s[40:41]
    ds_read_b128 v[24:27], v3 offset:7424
    s_mov_b64 exec, -1
    v_exp_f32 v39, v39
    v_exp_f32 v40, v40
    v_exp_f32 v41, v41
    v_mfma_f32_32x32x16_bf16 v[52:67], v[16:19], v[32:35], 0
    s_waitcnt lgkmcnt(1)
    v_exp_f32 v42, v42
    v_exp_f32 v43, v43
    v_exp_f32 v44, v44
    v_exp_f32 v45, v45
    v_exp_f32 v46, v46
    v_smfmac_f32_32x32x32_bf16 v[68:83], v[20:23], v[36:43], v5
    s_waitcnt lgkmcnt(0)
    ds_read_b128 v[16:19], v3 offset:34816
    v_exp_f32 v47, v47
    v_exp_f32 v48, v48
    v_exp_f32 v49, v49
    v_exp_f32 v50, v50
    v_exp_f32 v51, v51
    v_exp_f32 v52, v52
    v_exp_f32 v53, v53
    v_exp_f32 v54, v54
    v_smfmac_f32_32x32x32_bf16 v[68:83], v[24:27], v[44:51], v5
    s_setprio 1
    v_exp_f32 v55, v55
    v_exp_f32 v56, v56
    v_exp_f32 v57, v57
    v_mfma_f32_32x32x16_bf16 v[36:51], v[12:15], v[28:31], 0
    buffer_load_dwordx4 v2, s[24:27], s86 offen offset:1024 sc1 lds
    v_exp_f32 v58, v58
    v_exp_f32 v59, v59
    v_exp_f32 v60, v60
    v_exp_f32 v61, v61
    v_exp_f32 v62, v62
    v_smfmac_f32_32x32x32_bf16 v[84:99], v[20:23], v[52:59], v5
    s_mov_b64 exec, s[40:41]
    ds_read_b128 v[20:23], v3 offset:33792
    s_mov_b64 exec, -1
    v_exp_f32 v63, v63
    v_exp_f32 v64, v64
    v_exp_f32 v65, v65
    v_exp_f32 v66, v66
    v_exp_f32 v67, v67
    v_exp_f32 v36, v36
    v_exp_f32 v37, v37
    v_exp_f32 v38, v38
    v_smfmac_f32_32x32x32_bf16 v[84:99], v[24:27], v[60:67], v5
    s_mov_b64 exec, s[40:41]
    ds_read_b128 v[24:27], v3 offset:34048
    s_mov_b64 exec, -1
    v_exp_f32 v39, v39
    v_exp_f32 v40, v40
    v_exp_f32 v41, v41
    v_mfma_f32_32x32x16_bf16 v[52:67], v[12:15], v[32:35], 0
    s_waitcnt lgkmcnt(1)
    v_exp_f32 v42, v42
    v_exp_f32 v43, v43
    v_exp_f32 v44, v44
    v_exp_f32 v45, v45
    v_exp_f32 v46, v46
    v_smfmac_f32_32x32x32_bf16 v[68:83], v[20:23], v[36:43], v5
    s_waitcnt lgkmcnt(0)
    ds_read_b128 v[12:15], v3 offset:36864
    v_exp_f32 v47, v47
    v_exp_f32 v48, v48
    v_exp_f32 v49, v49
    v_exp_f32 v50, v50
    v_exp_f32 v51, v51
    v_exp_f32 v52, v52
    v_exp_f32 v53, v53
    v_exp_f32 v54, v54
    v_smfmac_f32_32x32x32_bf16 v[68:83], v[24:27], v[44:51], v5
    s_setprio 0
    v_exp_f32 v55, v55
    v_exp_f32 v56, v56
    v_exp_f32 v57, v57
    v_mfma_f32_32x32x16_bf16 v[36:51], v[16:19], v[28:31], 0
    buffer_load_dwordx4 v2, s[24:27], s86 offen offset:2048 sc1 lds
    v_exp_f32 v58, v58
    v_exp_f32 v59, v59
    v_exp_f32 v60, v60
    v_exp_f32 v61, v61
    v_exp_f32 v62, v62
    v_smfmac_f32_32x32x32_bf16 v[84:99], v[20:23], v[52:59], v5
    s_mov_b64 exec, s[40:41]
    ds_read_b128 v[20:23], v3 offset:35840
    s_mov_b64 exec, -1
    v_exp_f32 v63, v63
    v_exp_f32 v64, v64
    v_exp_f32 v65, v65
    v_exp_f32 v66, v66
    v_exp_f32 v67, v67
    v_exp_f32 v36, v36
    v_exp_f32 v37, v37
    v_exp_f32 v38, v38
    v_smfmac_f32_32x32x32_bf16 v[84:99], v[24:27], v[60:67], v5
    s_mov_b64 exec, s[40:41]
    ds_read_b128 v[24:27], v3 offset:36096
    s_mov_b64 exec, -1
    v_exp_f32 v39, v39
    v_exp_f32 v40, v40
    v_exp_f32 v41, v41
    v_mfma_f32_32x32x16_bf16 v[52:67], v[16:19], v[32:35], 0
    s_waitcnt lgkmcnt(1)
    v_exp_f32 v42, v42
    v_exp_f32 v43, v43
    v_exp_f32 v44, v44
    v_exp_f32 v45, v45
    v_exp_f32 v46, v46
    v_smfmac_f32_32x32x32_bf16 v[68:83], v[20:23], v[36:43], v5
    s_waitcnt lgkmcnt(0)
    ds_read_b128 v[16:19], v3 offset:38912
    v_exp_f32 v47, v47
    v_exp_f32 v48, v48
    v_exp_f32 v49, v49
    v_exp_f32 v50, v50
    v_exp_f32 v51, v51
    v_exp_f32 v52, v52
    v_exp_f32 v53, v53
    v_exp_f32 v54, v54
    v_smfmac_f32_32x32x32_bf16 v[68:83], v[24:27], v[44:51], v5
    v_exp_f32 v55, v55
    v_exp_f32 v56, v56
    v_exp_f32 v57, v57
    v_mfma_f32_32x32x16_bf16 v[36:51], v[12:15], v[28:31], 0
    buffer_load_dwordx4 v2, s[24:27], s86 offen offset:3072 sc1 lds
    v_exp_f32 v58, v58
    v_exp_f32 v59, v59
    v_exp_f32 v60, v60
    v_exp_f32 v61, v61
    v_exp_f32 v62, v62
    v_smfmac_f32_32x32x32_bf16 v[84:99], v[20:23], v[52:59], v5
    s_mov_b64 exec, s[40:41]
    ds_read_b128 v[20:23], v3 offset:37888
    s_mov_b64 exec, -1
    v_exp_f32 v63, v63
    v_exp_f32 v64, v64
    v_exp_f32 v65, v65
    v_exp_f32 v66, v66
    v_exp_f32 v67, v67
    s_waitcnt vmcnt(5)
    s_setprio 3
    s_barrier
    v_exp_f32 v36, v36
    v_exp_f32 v37, v37
    v_exp_f32 v38, v38
    v_smfmac_f32_32x32x32_bf16 v[84:99], v[24:27], v[60:67], v5
    s_add_u32 s86, s75, 15
    s_mov_b64 exec, s[40:41]
    ds_read_b128 v[24:27], v3 offset:38144
    s_mov_b64 exec, -1
    v_exp_f32 v39, v39
    v_exp_f32 v40, v40
    v_exp_f32 v41, v41
    v_mfma_f32_32x32x16_bf16 v[52:67], v[12:15], v[32:35], 0
    s_waitcnt lgkmcnt(1)
    s_and_b32 s86, s86, 15
    v_exp_f32 v42, v42
    v_exp_f32 v43, v43
    v_exp_f32 v44, v44
    v_exp_f32 v45, v45
    v_exp_f32 v46, v46
    v_smfmac_f32_32x32x32_bf16 v[68:83], v[20:23], v[36:43], v5
    s_waitcnt lgkmcnt(0)
    s_lshl_b32 s86, s86, 13
    s_add_u32 s86, s86, s62
    s_add_u32 m0, s63, 0
    ds_read_b128 v[12:15], v4 offset:0
    v_exp_f32 v47, v47
    v_exp_f32 v48, v48
    v_exp_f32 v49, v49
    v_exp_f32 v50, v50
    v_exp_f32 v51, v51
    v_exp_f32 v52, v52
    v_exp_f32 v53, v53
    v_exp_f32 v54, v54
    v_smfmac_f32_32x32x32_bf16 v[68:83], v[24:27], v[44:51], v5
    s_setprio 2
    v_exp_f32 v55, v55
    v_exp_f32 v56, v56
    v_exp_f32 v57, v57
    v_mfma_f32_32x32x16_bf16 v[36:51], v[16:19], v[28:31], 0
    buffer_load_dwordx4 v2, s[24:27], s86 offen offset:0 sc1 lds
    v_exp_f32 v58, v58
    v_exp_f32 v59, v59
    v_exp_f32 v60, v60
    v_exp_f32 v61, v61
    v_exp_f32 v62, v62
    v_smfmac_f32_32x32x32_bf16 v[84:99], v[20:23], v[52:59], v5
    s_mov_b64 exec, s[40:41]
    ds_read_b128 v[20:23], v3 offset:39936
    s_mov_b64 exec, -1
    v_exp_f32 v63, v63
    v_exp_f32 v64, v64
    v_exp_f32 v65, v65
    v_exp_f32 v66, v66
    v_exp_f32 v67, v67
    v_exp_f32 v36, v36
    v_exp_f32 v37, v37
    v_exp_f32 v38, v38
    v_smfmac_f32_32x32x32_bf16 v[84:99], v[24:27], v[60:67], v5
    s_mov_b64 exec, s[40:41]
    ds_read_b128 v[24:27], v3 offset:40192
    s_mov_b64 exec, -1
    v_exp_f32 v39, v39
    v_exp_f32 v40, v40
    v_exp_f32 v41, v41
    v_mfma_f32_32x32x16_bf16 v[52:67], v[16:19], v[32:35], 0
    s_waitcnt lgkmcnt(1)
    v_exp_f32 v42, v42
    v_exp_f32 v43, v43
    v_exp_f32 v44, v44
    v_exp_f32 v45, v45
    v_exp_f32 v46, v46
    v_smfmac_f32_32x32x32_bf16 v[68:83], v[20:23], v[36:43], v5
    s_waitcnt lgkmcnt(0)
    ds_read_b128 v[16:19], v4 offset:2048
    v_exp_f32 v47, v47
    v_exp_f32 v48, v48
    v_exp_f32 v49, v49
    v_exp_f32 v50, v50
    v_exp_f32 v51, v51
    v_exp_f32 v52, v52
    v_exp_f32 v53, v53
    v_exp_f32 v54, v54
    v_smfmac_f32_32x32x32_bf16 v[68:83], v[24:27], v[44:51], v5
    s_setprio 1
    v_exp_f32 v55, v55
    v_exp_f32 v56, v56
    v_exp_f32 v57, v57
    v_mfma_f32_32x32x16_bf16 v[36:51], v[12:15], v[28:31], 0
    buffer_load_dwordx4 v2, s[24:27], s86 offen offset:1024 sc1 lds
    v_exp_f32 v58, v58
    v_exp_f32 v59, v59
    v_exp_f32 v60, v60
    v_exp_f32 v61, v61
    v_exp_f32 v62, v62
    v_smfmac_f32_32x32x32_bf16 v[84:99], v[20:23], v[52:59], v5
    s_mov_b64 exec, s[40:41]
    ds_read_b128 v[20:23], v4 offset:1024
    s_mov_b64 exec, -1
    v_exp_f32 v63, v63
    v_exp_f32 v64, v64
    v_exp_f32 v65, v65
    v_exp_f32 v66, v66
    v_exp_f32 v67, v67
    v_exp_f32 v36, v36
    v_exp_f32 v37, v37
    v_exp_f32 v38, v38
    v_smfmac_f32_32x32x32_bf16 v[84:99], v[24:27], v[60:67], v5
    s_mov_b64 exec, s[40:41]
    ds_read_b128 v[24:27], v4 offset:1280
    s_mov_b64 exec, -1
    v_exp_f32 v39, v39
    v_exp_f32 v40, v40
    v_exp_f32 v41, v41
    v_mfma_f32_32x32x16_bf16 v[52:67], v[12:15], v[32:35], 0
    s_waitcnt lgkmcnt(1)
    v_exp_f32 v42, v42
    v_exp_f32 v43, v43
    v_exp_f32 v44, v44
    v_exp_f32 v45, v45
    v_exp_f32 v46, v46
    v_smfmac_f32_32x32x32_bf16 v[68:83], v[20:23], v[36:43], v5
    s_waitcnt lgkmcnt(0)
    ds_read_b128 v[12:15], v4 offset:4096
    v_exp_f32 v47, v47
    v_exp_f32 v48, v48
    v_exp_f32 v49, v49
    v_exp_f32 v50, v50
    v_exp_f32 v51, v51
    v_exp_f32 v52, v52
    v_exp_f32 v53, v53
    v_exp_f32 v54, v54
    v_smfmac_f32_32x32x32_bf16 v[68:83], v[24:27], v[44:51], v5
    s_setprio 0
    v_exp_f32 v55, v55
    v_exp_f32 v56, v56
    v_exp_f32 v57, v57
    v_mfma_f32_32x32x16_bf16 v[36:51], v[16:19], v[28:31], 0
    buffer_load_dwordx4 v2, s[24:27], s86 offen offset:2048 sc1 lds
    v_exp_f32 v58, v58
    v_exp_f32 v59, v59
    v_exp_f32 v60, v60
    v_exp_f32 v61, v61
    v_exp_f32 v62, v62
    v_smfmac_f32_32x32x32_bf16 v[84:99], v[20:23], v[52:59], v5
    s_mov_b64 exec, s[40:41]
    ds_read_b128 v[20:23], v4 offset:3072
    s_mov_b64 exec, -1
    v_exp_f32 v63, v63
    v_exp_f32 v64, v64
    v_exp_f32 v65, v65
    v_exp_f32 v66, v66
    v_exp_f32 v67, v67
    v_exp_f32 v36, v36
    v_exp_f32 v37, v37
    v_exp_f32 v38, v38
    v_smfmac_f32_32x32x32_bf16 v[84:99], v[24:27], v[60:67], v5
    s_mov_b64 exec, s[40:41]
    ds_read_b128 v[24:27], v4 offset:3328
    s_mov_b64 exec, -1
    v_exp_f32 v39, v39
    v_exp_f32 v40, v40
    v_exp_f32 v41, v41
    v_mfma_f32_32x32x16_bf16 v[52:67], v[16:19], v[32:35], 0
    s_waitcnt lgkmcnt(1)
    v_exp_f32 v42, v42
    v_exp_f32 v43, v43
    v_exp_f32 v44, v44
    v_exp_f32 v45, v45
    v_exp_f32 v46, v46
    v_smfmac_f32_32x32x32_bf16 v[68:83], v[20:23], v[36:43], v5
    s_waitcnt lgkmcnt(0)
    ds_read_b128 v[16:19], v4 offset:6144
    v_exp_f32 v47, v47
    v_exp_f32 v48, v48
    v_exp_f32 v49, v49
    v_exp_f32 v50, v50
    v_exp_f32 v51, v51
    v_exp_f32 v52, v52
    v_exp_f32 v53, v53
    v_exp_f32 v54, v54
    v_smfmac_f32_32x32x32_bf16 v[68:83], v[24:27], v[44:51], v5
    v_exp_f32 v55, v55
    v_exp_f32 v56, v56
    v_exp_f32 v57, v57
    v_mfma_f32_32x32x16_bf16 v[36:51], v[12:15], v[28:31], 0
    buffer_load_dwordx4 v2, s[24:27], s86 offen offset:3072 sc1 lds
    v_exp_f32 v58, v58
    v_exp_f32 v59, v59
    v_exp_f32 v60, v60
    v_exp_f32 v61, v61
    v_exp_f32 v62, v62
    v_smfmac_f32_32x32x32_bf16 v[84:99], v[20:23], v[52:59], v5
    s_mov_b64 exec, s[40:41]
    ds_read_b128 v[20:23], v4 offset:5120
    s_mov_b64 exec, -1
    v_exp_f32 v63, v63
    v_exp_f32 v64, v64
    v_exp_f32 v65, v65
    v_exp_f32 v66, v66
    v_exp_f32 v67, v67
    s_waitcnt vmcnt(4)
    s_setprio 3
    s_barrier
    v_exp_f32 v36, v36
    v_exp_f32 v37, v37
    v_exp_f32 v38, v38
    v_smfmac_f32_32x32x32_bf16 v[84:99], v[24:27], v[60:67], v5
    s_xor_b32 s86, s31, 1
    s_mov_b64 exec, s[40:41]
    ds_read_b128 v[24:27], v4 offset:5376
    s_mov_b64 exec, -1
    v_exp_f32 v39, v39
    v_exp_f32 v40, v40
    v_exp_f32 v41, v41
    v_mfma_f32_32x32x16_bf16 v[52:67], v[12:15], v[32:35], 0
    s_waitcnt lgkmcnt(1)
    v_exp_f32 v42, v42
    v_exp_f32 v43, v43
    v_exp_f32 v44, v44
    v_exp_f32 v45, v45
    v_exp_f32 v46, v46
    v_smfmac_f32_32x32x32_bf16 v[68:83], v[20:23], v[36:43], v5
    s_waitcnt lgkmcnt(0)
    s_lshl_b32 s86, s86, 13
    s_add_u32 s86, s86, s62
    ds_read_b128 v[12:15], v4 offset:32768
    v_exp_f32 v47, v47
    v_exp_f32 v48, v48
    v_exp_f32 v49, v49
    v_exp_f32 v50, v50
    v_exp_f32 v51, v51
    v_exp_f32 v52, v52
    v_exp_f32 v53, v53
    v_exp_f32 v54, v54
    v_smfmac_f32_32x32x32_bf16 v[68:83], v[24:27], v[44:51], v5
    s_add_u32 m0, s63, 32768
    s_setprio 2
    buffer_load_dwordx4 v2, s[24:27], s86 offen offset:0 sc1 lds
    v_exp_f32 v55, v55
    v_exp_f32 v56, v56
    v_exp_f32 v57, v57
    v_mfma_f32_32x32x16_bf16 v[36:51], v[16:19], v[28:31], 0
    s_add_u32 m0, s63, 131072
    s_mov_b32 s35, 0
    buffer_load_dwordx4 v10, s[48:51], s35 offen lds
    v_exp_f32 v58, v58
    v_exp_f32 v59, v59
    v_exp_f32 v60, v60
    v_exp_f32 v61, v61
    v_exp_f32 v62, v62
    v_smfmac_f32_32x32x32_bf16 v[84:99], v[20:23], v[52:59], v5
    s_mov_b64 exec, s[40:41]
    ds_read_b128 v[20:23], v4 offset:7168
    s_mov_b64 exec, -1
    v_exp_f32 v63, v63
    v_exp_f32 v64, v64
    v_exp_f32 v65, v65
    v_exp_f32 v66, v66
    v_exp_f32 v67, v67
    v_exp_f32 v36, v36
    v_exp_f32 v37, v37
    v_exp_f32 v38, v38
    v_smfmac_f32_32x32x32_bf16 v[84:99], v[24:27], v[60:67], v5
    s_mov_b64 exec, s[40:41]
    ds_read_b128 v[24:27], v4 offset:7424
    s_mov_b64 exec, -1
    v_exp_f32 v39, v39
    v_exp_f32 v40, v40
    v_exp_f32 v41, v41
    v_mfma_f32_32x32x16_bf16 v[52:67], v[16:19], v[32:35], 0
    s_waitcnt lgkmcnt(1)
    v_exp_f32 v42, v42
    v_exp_f32 v43, v43
    v_exp_f32 v44, v44
    v_exp_f32 v45, v45
    v_exp_f32 v46, v46
    v_smfmac_f32_32x32x32_bf16 v[68:83], v[20:23], v[36:43], v5
    s_waitcnt lgkmcnt(0)
    ds_read_b128 v[16:19], v4 offset:34816
    v_exp_f32 v47, v47
    v_exp_f32 v48, v48
    v_exp_f32 v49, v49
    v_exp_f32 v50, v50
    v_exp_f32 v51, v51
    v_exp_f32 v52, v52
    v_exp_f32 v53, v53
    v_exp_f32 v54, v54
    v_smfmac_f32_32x32x32_bf16 v[68:83], v[24:27], v[44:51], v5
    s_add_u32 m0, s63, 32768
    s_setprio 1
    buffer_load_dwordx4 v2, s[24:27], s86 offen offset:1024 sc1 lds
    v_exp_f32 v55, v55
    v_exp_f32 v56, v56
    v_exp_f32 v57, v57
    v_mfma_f32_32x32x16_bf16 v[36:51], v[12:15], v[28:31], 0
    s_add_u32 m0, s63, 132096
    s_mov_b32 s35, 4096
    buffer_load_dwordx4 v10, s[48:51], s35 offen lds
    v_exp_f32 v58, v58
    v_exp_f32 v59, v59
    v_exp_f32 v60, v60
    v_exp_f32 v61, v61
    v_exp_f32 v62, v62
    v_smfmac_f32_32x32x32_bf16 v[84:99], v[20:23], v[52:59], v5
    s_mov_b64 exec, s[40:41]
    ds_read_b128 v[20:23], v4 offset:33792
    s_mov_b64 exec, -1
    v_exp_f32 v63, v63
    v_exp_f32 v64, v64
    v_exp_f32 v65, v65
    v_exp_f32 v66, v66
    v_exp_f32 v67, v67
    v_exp_f32 v36, v36
    v_exp_f32 v37, v37
    v_exp_f32 v38, v38
    v_smfmac_f32_32x32x32_bf16 v[84:99], v[24:27], v[60:67], v5
    s_mov_b64 exec, s[40:41]
    ds_read_b128 v[24:27], v4 offset:34048
    s_mov_b64 exec, -1
    v_exp_f32 v39, v39
    v_exp_f32 v40, v40
    v_exp_f32 v41, v41
    v_mfma_f32_32x32x16_bf16 v[52:67], v[12:15], v[32:35], 0
    s_waitcnt lgkmcnt(1)
    v_exp_f32 v42, v42
    v_exp_f32 v43, v43
    v_exp_f32 v44, v44
    v_exp_f32 v45, v45
    v_exp_f32 v46, v46
    v_smfmac_f32_32x32x32_bf16 v[68:83], v[20:23], v[36:43], v5
    s_waitcnt lgkmcnt(0)
    ds_read_b128 v[12:15], v4 offset:36864
    v_exp_f32 v47, v47
    v_exp_f32 v48, v48
    v_exp_f32 v49, v49
    v_exp_f32 v50, v50
    v_exp_f32 v51, v51
    v_exp_f32 v52, v52
    v_exp_f32 v53, v53
    v_exp_f32 v54, v54
    v_smfmac_f32_32x32x32_bf16 v[68:83], v[24:27], v[44:51], v5
    s_add_u32 m0, s63, 32768
    s_setprio 0
    buffer_load_dwordx4 v2, s[24:27], s86 offen offset:2048 sc1 lds
    v_exp_f32 v55, v55
    v_exp_f32 v56, v56
    v_exp_f32 v57, v57
    v_mfma_f32_32x32x16_bf16 v[36:51], v[16:19], v[28:31], 0
    s_add_u32 m0, s63, 133120
    s_mov_b32 s35, 8192
    buffer_load_dwordx4 v10, s[48:51], s35 offen lds
    v_exp_f32 v58, v58
    v_exp_f32 v59, v59
    v_exp_f32 v60, v60
    v_exp_f32 v61, v61
    v_exp_f32 v62, v62
    v_smfmac_f32_32x32x32_bf16 v[84:99], v[20:23], v[52:59], v5
    s_mov_b64 exec, s[40:41]
    ds_read_b128 v[20:23], v4 offset:35840
    s_mov_b64 exec, -1
    v_exp_f32 v63, v63
    v_exp_f32 v64, v64
    v_exp_f32 v65, v65
    v_exp_f32 v66, v66
    v_exp_f32 v67, v67
    v_exp_f32 v36, v36
    v_exp_f32 v37, v37
    v_exp_f32 v38, v38
    v_smfmac_f32_32x32x32_bf16 v[84:99], v[24:27], v[60:67], v5
    s_mov_b64 exec, s[40:41]
    ds_read_b128 v[24:27], v4 offset:36096
    s_mov_b64 exec, -1
    v_exp_f32 v39, v39
    v_exp_f32 v40, v40
    v_exp_f32 v41, v41
    v_mfma_f32_32x32x16_bf16 v[52:67], v[16:19], v[32:35], 0
    s_waitcnt lgkmcnt(1)
    v_exp_f32 v42, v42
    v_exp_f32 v43, v43
    v_exp_f32 v44, v44
    v_exp_f32 v45, v45
    v_exp_f32 v46, v46
    v_smfmac_f32_32x32x32_bf16 v[68:83], v[20:23], v[36:43], v5
    s_waitcnt lgkmcnt(0)
    ds_read_b128 v[16:19], v4 offset:38912
    v_exp_f32 v47, v47
    v_exp_f32 v48, v48
    v_exp_f32 v49, v49
    v_exp_f32 v50, v50
    v_exp_f32 v51, v51
    v_exp_f32 v52, v52
    v_exp_f32 v53, v53
    v_exp_f32 v54, v54
    v_smfmac_f32_32x32x32_bf16 v[68:83], v[24:27], v[44:51], v5
    s_add_u32 m0, s63, 32768
    s_nop 0
    buffer_load_dwordx4 v2, s[24:27], s86 offen offset:3072 sc1 lds
    v_exp_f32 v55, v55
    v_exp_f32 v56, v56
    v_exp_f32 v57, v57
    v_mfma_f32_32x32x16_bf16 v[36:51], v[12:15], v[28:31], 0
    s_add_u32 m0, s63, 134144
    s_mov_b32 s35, 12288
    buffer_load_dwordx4 v10, s[48:51], s35 offen lds
    v_exp_f32 v58, v58
    v_exp_f32 v59, v59
    v_exp_f32 v60, v60
    v_exp_f32 v61, v61
    v_exp_f32 v62, v62
    v_smfmac_f32_32x32x32_bf16 v[84:99], v[20:23], v[52:59], v5
    s_mov_b64 exec, s[40:41]
    ds_read_b128 v[20:23], v4 offset:37888
    s_mov_b64 exec, -1
    v_exp_f32 v63, v63
    v_exp_f32 v64, v64
    v_exp_f32 v65, v65
    v_exp_f32 v66, v66
    v_exp_f32 v67, v67
    s_waitcnt vmcnt(8)
    s_setprio 3
    s_barrier
    v_exp_f32 v36, v36
    v_exp_f32 v37, v37
    v_exp_f32 v38, v38
    v_smfmac_f32_32x32x32_bf16 v[84:99], v[24:27], v[60:67], v5
    s_xor_b32 s86, s31, 2
    s_mov_b64 exec, s[40:41]
    ds_read_b128 v[24:27], v4 offset:38144
    s_mov_b64 exec, -1
    v_exp_f32 v39, v39
    v_exp_f32 v40, v40
    v_exp_f32 v41, v41
    v_mfma_f32_32x32x16_bf16 v[52:67], v[12:15], v[32:35], 0
    s_waitcnt lgkmcnt(1)
    v_exp_f32 v42, v42
    v_exp_f32 v43, v43
    v_exp_f32 v44, v44
    v_exp_f32 v45, v45
    v_exp_f32 v46, v46
    v_smfmac_f32_32x32x32_bf16 v[68:83], v[20:23], v[36:43], v5
    s_waitcnt lgkmcnt(0)
    s_lshl_b32 s86, s86, 13
    s_add_u32 s86, s86, s62
    s_add_u32 m0, s63, 65536
    ds_read_b128 v[12:15], v3 offset:0
    v_exp_f32 v47, v47
    v_exp_f32 v48, v48
    v_exp_f32 v49, v49
    v_exp_f32 v50, v50
    v_exp_f32 v51, v51
    v_exp_f32 v52, v52
    v_exp_f32 v53, v53
    v_exp_f32 v54, v54
    v_smfmac_f32_32x32x32_bf16 v[68:83], v[24:27], v[44:51], v5
    s_setprio 2
    v_exp_f32 v55, v55
    v_exp_f32 v56, v56
    v_exp_f32 v57, v57
    v_mfma_f32_32x32x16_bf16 v[36:51], v[16:19], v[28:31], 0
    buffer_load_dwordx4 v2, s[24:27], s86 offen offset:0 sc1 lds
    v_exp_f32 v58, v58
    v_exp_f32 v59, v59
    v_exp_f32 v60, v60
    v_exp_f32 v61, v61
    v_exp_f32 v62, v62
    v_smfmac_f32_32x32x32_bf16 v[84:99], v[20:23], v[52:59], v5
    s_mov_b64 exec, s[40:41]
    ds_read_b128 v[20:23], v4 offset:39936
    s_mov_b64 exec, -1
    v_exp_f32 v63, v63
    v_exp_f32 v64, v64
    v_exp_f32 v65, v65
    v_exp_f32 v66, v66
    v_exp_f32 v67, v67
    v_exp_f32 v36, v36
    v_exp_f32 v37, v37
    v_exp_f32 v38, v38
    v_smfmac_f32_32x32x32_bf16 v[84:99], v[24:27], v[60:67], v5
    s_mov_b64 exec, s[40:41]
    ds_read_b128 v[24:27], v4 offset:40192
    s_mov_b64 exec, -1
    v_exp_f32 v39, v39
    v_exp_f32 v40, v40
    v_exp_f32 v41, v41
    v_mfma_f32_32x32x16_bf16 v[52:67], v[16:19], v[32:35], 0
    s_waitcnt lgkmcnt(1)
    v_exp_f32 v42, v42
    v_exp_f32 v43, v43
    v_exp_f32 v44, v44
    v_exp_f32 v45, v45
    v_exp_f32 v46, v46
    v_smfmac_f32_32x32x32_bf16 v[68:83], v[20:23], v[36:43], v5
    s_waitcnt lgkmcnt(0)
    ds_read_b128 v[16:19], v3 offset:2048
    v_exp_f32 v47, v47
    v_exp_f32 v48, v48
    v_exp_f32 v49, v49
    v_exp_f32 v50, v50
    v_exp_f32 v51, v51
    v_exp_f32 v52, v52
    v_exp_f32 v53, v53
    v_exp_f32 v54, v54
    v_smfmac_f32_32x32x32_bf16 v[68:83], v[24:27], v[44:51], v5
    s_setprio 1
    v_exp_f32 v55, v55
    v_exp_f32 v56, v56
    v_exp_f32 v57, v57
    v_mfma_f32_32x32x16_bf16 v[36:51], v[12:15], v[28:31], 0
    buffer_load_dwordx4 v2, s[24:27], s86 offen offset:1024 sc1 lds
    v_exp_f32 v58, v58
    v_exp_f32 v59, v59
    v_exp_f32 v60, v60
    v_exp_f32 v61, v61
    v_exp_f32 v62, v62
    v_smfmac_f32_32x32x32_bf16 v[84:99], v[20:23], v[52:59], v5
    s_mov_b64 exec, s[40:41]
    ds_read_b128 v[20:23], v3 offset:1024
    s_mov_b64 exec, -1
    v_exp_f32 v63, v63
    v_exp_f32 v64, v64
    v_exp_f32 v65, v65
    v_exp_f32 v66, v66
    v_exp_f32 v67, v67
    v_exp_f32 v36, v36
    v_exp_f32 v37, v37
    v_exp_f32 v38, v38
    v_smfmac_f32_32x32x32_bf16 v[84:99], v[24:27], v[60:67], v5
    s_mov_b64 exec, s[40:41]
    ds_read_b128 v[24:27], v3 offset:1280
    s_mov_b64 exec, -1
    v_exp_f32 v39, v39
    v_exp_f32 v40, v40
    v_exp_f32 v41, v41
    v_mfma_f32_32x32x16_bf16 v[52:67], v[12:15], v[32:35], 0
    s_waitcnt lgkmcnt(1)
    v_exp_f32 v42, v42
    v_exp_f32 v43, v43
    v_exp_f32 v44, v44
    v_exp_f32 v45, v45
    v_exp_f32 v46, v46
    v_smfmac_f32_32x32x32_bf16 v[68:83], v[20:23], v[36:43], v5
    s_waitcnt lgkmcnt(0)
    ds_read_b128 v[12:15], v3 offset:4096
    v_exp_f32 v47, v47
    v_exp_f32 v48, v48
    v_exp_f32 v49, v49
    v_exp_f32 v50, v50
    v_exp_f32 v51, v51
    v_exp_f32 v52, v52
    v_exp_f32 v53, v53
    v_exp_f32 v54, v54
    v_smfmac_f32_32x32x32_bf16 v[68:83], v[24:27], v[44:51], v5
    s_setprio 0
    v_exp_f32 v55, v55
    v_exp_f32 v56, v56
    v_exp_f32 v57, v57
    v_mfma_f32_32x32x16_bf16 v[36:51], v[16:19], v[28:31], 0
    buffer_load_dwordx4 v2, s[24:27], s86 offen offset:2048 sc1 lds
    v_exp_f32 v58, v58
    v_exp_f32 v59, v59
    v_exp_f32 v60, v60
    v_exp_f32 v61, v61
    v_exp_f32 v62, v62
    v_smfmac_f32_32x32x32_bf16 v[84:99], v[20:23], v[52:59], v5
    s_mov_b64 exec, s[40:41]
    ds_read_b128 v[20:23], v3 offset:3072
    s_mov_b64 exec, -1
    v_exp_f32 v63, v63
    v_exp_f32 v64, v64
    v_exp_f32 v65, v65
    v_exp_f32 v66, v66
    v_exp_f32 v67, v67
    v_exp_f32 v36, v36
    v_exp_f32 v37, v37
    v_exp_f32 v38, v38
    v_smfmac_f32_32x32x32_bf16 v[84:99], v[24:27], v[60:67], v5
    s_mov_b64 exec, s[40:41]
    ds_read_b128 v[24:27], v3 offset:3328
    s_mov_b64 exec, -1
    v_exp_f32 v39, v39
    v_exp_f32 v40, v40
    v_exp_f32 v41, v41
    v_mfma_f32_32x32x16_bf16 v[52:67], v[16:19], v[32:35], 0
    s_waitcnt lgkmcnt(1)
    v_exp_f32 v42, v42
    v_exp_f32 v43, v43
    v_exp_f32 v44, v44
    v_exp_f32 v45, v45
    v_exp_f32 v46, v46
    v_smfmac_f32_32x32x32_bf16 v[68:83], v[20:23], v[36:43], v5
    s_waitcnt lgkmcnt(0)
    ds_read_b128 v[16:19], v3 offset:6144
    v_exp_f32 v47, v47
    v_exp_f32 v48, v48
    v_exp_f32 v49, v49
    v_exp_f32 v50, v50
    v_exp_f32 v51, v51
    v_exp_f32 v52, v52
    v_exp_f32 v53, v53
    v_exp_f32 v54, v54
    v_smfmac_f32_32x32x32_bf16 v[68:83], v[24:27], v[44:51], v5
    v_exp_f32 v55, v55
    v_exp_f32 v56, v56
    v_exp_f32 v57, v57
    v_mfma_f32_32x32x16_bf16 v[36:51], v[12:15], v[28:31], 0
    buffer_load_dwordx4 v2, s[24:27], s86 offen offset:3072 sc1 lds
    v_exp_f32 v58, v58
    v_exp_f32 v59, v59
    v_exp_f32 v60, v60
    v_exp_f32 v61, v61
    v_exp_f32 v62, v62
    v_smfmac_f32_32x32x32_bf16 v[84:99], v[20:23], v[52:59], v5
    s_mov_b64 exec, s[40:41]
    ds_read_b128 v[20:23], v3 offset:5120
    s_mov_b64 exec, -1
    v_exp_f32 v63, v63
    v_exp_f32 v64, v64
    v_exp_f32 v65, v65
    v_exp_f32 v66, v66
    v_exp_f32 v67, v67
    s_waitcnt vmcnt(4)
    s_setprio 3
    s_barrier
    v_exp_f32 v36, v36
    v_exp_f32 v37, v37
    v_exp_f32 v38, v38
    v_smfmac_f32_32x32x32_bf16 v[84:99], v[24:27], v[60:67], v5
    s_xor_b32 s86, s31, 3
    s_mov_b64 exec, s[40:41]
    ds_read_b128 v[24:27], v3 offset:5376
    s_mov_b64 exec, -1
    v_exp_f32 v39, v39
    v_exp_f32 v40, v40
    v_exp_f32 v41, v41
    v_mfma_f32_32x32x16_bf16 v[52:67], v[12:15], v[32:35], 0
    s_waitcnt lgkmcnt(1)
    ds_read_b64_tr_b16 v[100:101], v231 offset:0
    v_exp_f32 v42, v42
    v_exp_f32 v43, v43
    v_exp_f32 v44, v44
    v_exp_f32 v45, v45
    v_exp_f32 v46, v46
    v_smfmac_f32_32x32x32_bf16 v[68:83], v[20:23], v[36:43], v5
    s_waitcnt lgkmcnt(1)
    s_lshl_b32 s86, s86, 13
    s_add_u32 s86, s86, s62
    s_add_u32 m0, s63, 98304
    ds_read_b128 v[12:15], v3 offset:32768
    v_exp_f32 v47, v47
    v_exp_f32 v48, v48
    v_exp_f32 v49, v49
    v_exp_f32 v50, v50
    v_exp_f32 v51, v51
    v_exp_f32 v52, v52
    v_exp_f32 v53, v53
    v_exp_f32 v54, v54
    v_smfmac_f32_32x32x32_bf16 v[68:83], v[24:27], v[44:51], v5
    s_setprio 2
    ds_read_b64_tr_b16 v[102:103], v231 offset:2048
    ds_read_b64_tr_b16 v[104:105], v231 offset:4096
    v_exp_f32 v55, v55
    v_exp_f32 v56, v56
    v_exp_f32 v57, v57
    v_mfma_f32_32x32x16_bf16 v[36:51], v[16:19], v[28:31], 0
    buffer_load_dwordx4 v2, s[24:27], s86 offen offset:0 sc1 lds
    v_exp_f32 v58, v58
    v_exp_f32 v59, v59
    v_exp_f32 v60, v60
    v_exp_f32 v61, v61
    v_exp_f32 v62, v62
    v_smfmac_f32_32x32x32_bf16 v[84:99], v[20:23], v[52:59], v5
    ds_read_b64_tr_b16 v[106:107], v231 offset:6144
    s_mov_b64 exec, s[40:41]
    ds_read_b128 v[20:23], v3 offset:7168
    s_mov_b64 exec, -1
    v_exp_f32 v63, v63
    v_exp_f32 v64, v64
    v_exp_f32 v65, v65
    v_exp_f32 v66, v66
    v_exp_f32 v67, v67
    v_exp_f32 v36, v36
    v_exp_f32 v37, v37
    v_exp_f32 v38, v38
    v_smfmac_f32_32x32x32_bf16 v[84:99], v[24:27], v[60:67], v5
    s_mov_b64 exec, s[40:41]
    ds_read_b128 v[24:27], v3 offset:7424
    s_mov_b64 exec, -1
    v_exp_f32 v39, v39
    v_exp_f32 v40, v40
    v_exp_f32 v41, v41
    v_mfma_f32_32x32x16_bf16 v[52:67], v[16:19], v[32:35], 0
    s_waitcnt lgkmcnt(1)
    ds_read_b64_tr_b16 v[108:109], v231 offset:8192
    v_exp_f32 v42, v42
    v_exp_f32 v43, v43
    v_exp_f32 v44, v44
    v_exp_f32 v45, v45
    v_exp_f32 v46, v46
    v_smfmac_f32_32x32x32_bf16 v[68:83], v[20:23], v[36:43], v5
    s_waitcnt lgkmcnt(1)
    ds_read_b128 v[16:19], v3 offset:34816
    v_exp_f32 v47, v47
    v_exp_f32 v48, v48
    v_exp_f32 v49, v49
    v_exp_f32 v50, v50
    v_exp_f32 v51, v51
    v_exp_f32 v52, v52
    v_exp_f32 v53, v53
    v_exp_f32 v54, v54
    v_smfmac_f32_32x32x32_bf16 v[68:83], v[24:27], v[44:51], v5
    s_setprio 1
    ds_read_b64_tr_b16 v[110:111], v231 offset:10240
    ds_read_b64_tr_b16 v[112:113], v231 offset:12288
    v_exp_f32 v55, v55
    v_exp_f32 v56, v56
    v_exp_f32 v57, v57
    v_mfma_f32_32x32x16_bf16 v[36:51], v[12:15], v[28:31], 0
    buffer_load_dwordx4 v2, s[24:27], s86 offen offset:1024 sc1 lds
    v_exp_f32 v58, v58
    v_exp_f32 v59, v59
    v_exp_f32 v60, v60
    v_exp_f32 v61, v61
    v_exp_f32 v62, v62
    v_smfmac_f32_32x32x32_bf16 v[84:99], v[20:23], v[52:59], v5
    ds_read_b64_tr_b16 v[114:115], v231 offset:14336
    s_mov_b64 exec, s[40:41]
    ds_read_b128 v[20:23], v3 offset:33792
    s_mov_b64 exec, -1
    v_exp_f32 v63, v63
    v_exp_f32 v64, v64
    v_exp_f32 v65, v65
    v_exp_f32 v66, v66
    v_exp_f32 v67, v67
    v_exp_f32 v36, v36
    v_exp_f32 v37, v37
    v_exp_f32 v38, v38
    v_smfmac_f32_32x32x32_bf16 v[84:99], v[24:27], v[60:67], v5
    s_mov_b64 exec, s[40:41]
    ds_read_b128 v[24:27], v3 offset:34048
    s_mov_b64 exec, -1
    v_exp_f32 v39, v39
    v_exp_f32 v40, v40
    v_exp_f32 v41, v41
    v_mfma_f32_32x32x16_bf16 v[52:67], v[12:15], v[32:35], 0
    s_waitcnt lgkmcnt(1)
    ds_read_b64_tr_b16 v[116:117], v231 offset:16384
    v_exp_f32 v42, v42
    v_exp_f32 v43, v43
    v_exp_f32 v44, v44
    v_exp_f32 v45, v45
    v_exp_f32 v46, v46
    v_smfmac_f32_32x32x32_bf16 v[68:83], v[20:23], v[36:43], v5
    s_waitcnt lgkmcnt(1)
    ds_read_b128 v[12:15], v3 offset:36864
    v_exp_f32 v47, v47
    v_exp_f32 v48, v48
    v_exp_f32 v49, v49
    v_exp_f32 v50, v50
    v_exp_f32 v51, v51
    v_exp_f32 v52, v52
    v_exp_f32 v53, v53
    v_exp_f32 v54, v54
    v_smfmac_f32_32x32x32_bf16 v[68:83], v[24:27], v[44:51], v5
    s_setprio 0
    ds_read_b64_tr_b16 v[118:119], v231 offset:18432
    ds_read_b64_tr_b16 v[120:121], v231 offset:20480
    v_exp_f32 v55, v55
    v_exp_f32 v56, v56
    v_exp_f32 v57, v57
    v_mfma_f32_32x32x16_bf16 v[36:51], v[16:19], v[28:31], 0
    buffer_load_dwordx4 v2, s[24:27], s86 offen offset:2048 sc1 lds
    v_exp_f32 v58, v58
    v_exp_f32 v59, v59
    v_exp_f32 v60, v60
    v_exp_f32 v61, v61
    v_exp_f32 v62, v62
    v_smfmac_f32_32x32x32_bf16 v[84:99], v[20:23], v[52:59], v5
    ds_read_b64_tr_b16 v[122:123], v231 offset:22528
    s_mov_b64 exec, s[40:41]
    ds_read_b128 v[20:23], v3 offset:35840
    s_mov_b64 exec, -1
    v_exp_f32 v63, v63
    v_exp_f32 v64, v64
    v_exp_f32 v65, v65
    v_exp_f32 v66, v66
    v_exp_f32 v67, v67
    v_exp_f32 v36, v36
    v_exp_f32 v37, v37
    v_exp_f32 v38, v38
    v_smfmac_f32_32x32x32_bf16 v[84:99], v[24:27], v[60:67], v5
    s_mov_b64 exec, s[40:41]
    ds_read_b128 v[24:27], v3 offset:36096
    s_mov_b64 exec, -1
    v_exp_f32 v39, v39
    v_exp_f32 v40, v40
    v_exp_f32 v41, v41
    v_mfma_f32_32x32x16_bf16 v[52:67], v[16:19], v[32:35], 0
    s_waitcnt lgkmcnt(1)
    ds_read_b64_tr_b16 v[124:125], v231 offset:24576
    v_exp_f32 v42, v42
    v_exp_f32 v43, v43
    v_exp_f32 v44, v44
    v_exp_f32 v45, v45
    v_exp_f32 v46, v46
    v_smfmac_f32_32x32x32_bf16 v[68:83], v[20:23], v[36:43], v5
    s_waitcnt lgkmcnt(1)
    ds_read_b128 v[16:19], v3 offset:38912
    v_exp_f32 v47, v47
    v_exp_f32 v48, v48
    v_exp_f32 v49, v49
    v_exp_f32 v50, v50
    v_exp_f32 v51, v51
    v_exp_f32 v52, v52
    v_exp_f32 v53, v53
    v_exp_f32 v54, v54
    v_smfmac_f32_32x32x32_bf16 v[68:83], v[24:27], v[44:51], v5
    ds_read_b64_tr_b16 v[126:127], v231 offset:26624
    ds_read_b64_tr_b16 v[128:129], v231 offset:28672
    v_exp_f32 v55, v55
    v_exp_f32 v56, v56
    v_exp_f32 v57, v57
    v_mfma_f32_32x32x16_bf16 v[36:51], v[12:15], v[28:31], 0
    buffer_load_dwordx4 v2, s[24:27], s86 offen offset:3072 sc1 lds
    v_exp_f32 v58, v58
    v_exp_f32 v59, v59
    v_exp_f32 v60, v60
    v_exp_f32 v61, v61
    v_exp_f32 v62, v62
    v_smfmac_f32_32x32x32_bf16 v[84:99], v[20:23], v[52:59], v5
    ds_read_b64_tr_b16 v[130:131], v231 offset:30720
    s_mov_b64 exec, s[40:41]
    ds_read_b128 v[20:23], v3 offset:37888
    s_mov_b64 exec, -1
    v_exp_f32 v63, v63
    v_exp_f32 v64, v64
    v_exp_f32 v65, v65
    v_exp_f32 v66, v66
    v_exp_f32 v67, v67
    s_waitcnt vmcnt(4)
    s_waitcnt lgkmcnt(1)
    s_setprio 3
    s_barrier
    v_exp_f32 v36, v36
    v_exp_f32 v37, v37
    v_exp_f32 v38, v38
    v_smfmac_f32_32x32x32_bf16 v[84:99], v[24:27], v[60:67], v5
    s_mov_b64 exec, s[40:41]
    ds_read_b128 v[24:27], v3 offset:38144
    s_mov_b64 exec, -1
    v_exp_f32 v39, v39
    v_exp_f32 v40, v40
    v_exp_f32 v41, v41
    v_mfma_f32_32x32x16_bf16 v[52:67], v[12:15], v[32:35], 0
    s_waitcnt lgkmcnt(1)
    v_exp_f32 v42, v42
    v_exp_f32 v43, v43
    v_exp_f32 v44, v44
    v_exp_f32 v45, v45
    v_exp_f32 v46, v46
    v_smfmac_f32_32x32x32_bf16 v[68:83], v[20:23], v[36:43], v5
    s_waitcnt lgkmcnt(0)
    ds_read_b128 v[12:15], v4 offset:0
    v_exp_f32 v47, v47
    v_exp_f32 v48, v48
    v_exp_f32 v49, v49
    v_exp_f32 v50, v50
    v_exp_f32 v51, v51
    v_exp_f32 v52, v52
    v_exp_f32 v53, v53
    v_exp_f32 v54, v54
    v_smfmac_f32_32x32x32_bf16 v[68:83], v[24:27], v[44:51], v5
    s_setprio 2
    s_add_u32 m0, s63, 0
    s_mov_b32 s35, 131072
    buffer_load_dwordx4 v10, s[48:51], s35 offen lds
    v_exp_f32 v55, v55
    v_exp_f32 v56, v56
    v_exp_f32 v57, v57
    v_mfma_f32_32x32x16_bf16 v[36:51], v[16:19], v[28:31], 0
    s_add_u32 m0, s63, 131072
    s_mov_b32 s35, 393216
    buffer_load_dwordx4 v10, s[48:51], s35 offen lds
    v_exp_f32 v58, v58
    v_exp_f32 v59, v59
    v_exp_f32 v60, v60
    v_exp_f32 v61, v61
    v_exp_f32 v62, v62
    v_smfmac_f32_32x32x32_bf16 v[84:99], v[20:23], v[52:59], v5
    s_mov_b64 exec, s[40:41]
    ds_read_b128 v[20:23], v3 offset:39936
    s_mov_b64 exec, -1
    v_exp_f32 v63, v63
    v_exp_f32 v64, v64
    v_exp_f32 v65, v65
    v_exp_f32 v66, v66
    v_exp_f32 v67, v67
    v_exp_f32 v36, v36
    v_exp_f32 v37, v37
    v_exp_f32 v38, v38
    v_smfmac_f32_32x32x32_bf16 v[84:99], v[24:27], v[60:67], v5
    s_mov_b64 exec, s[40:41]
    ds_read_b128 v[24:27], v3 offset:40192
    s_mov_b64 exec, -1
    v_exp_f32 v39, v39
    v_exp_f32 v40, v40
    v_exp_f32 v41, v41
    v_mfma_f32_32x32x16_bf16 v[52:67], v[16:19], v[32:35], 0
    s_waitcnt lgkmcnt(1)
    v_exp_f32 v42, v42
    v_exp_f32 v43, v43
    v_exp_f32 v44, v44
    v_exp_f32 v45, v45
    v_exp_f32 v46, v46
    v_smfmac_f32_32x32x32_bf16 v[68:83], v[20:23], v[36:43], v5
    s_waitcnt lgkmcnt(0)
    ds_read_b128 v[16:19], v4 offset:2048
    v_exp_f32 v47, v47
    v_exp_f32 v48, v48
    v_exp_f32 v49, v49
    v_exp_f32 v50, v50
    v_exp_f32 v51, v51
    v_exp_f32 v52, v52
    v_exp_f32 v53, v53
    v_exp_f32 v54, v54
    v_smfmac_f32_32x32x32_bf16 v[68:83], v[24:27], v[44:51], v5
    s_setprio 1
    s_add_u32 m0, s63, 1024
    s_mov_b32 s35, 135168
    buffer_load_dwordx4 v10, s[48:51], s35 offen lds
    v_exp_f32 v55, v55
    v_exp_f32 v56, v56
    v_exp_f32 v57, v57
    v_mfma_f32_32x32x16_bf16 v[36:51], v[12:15], v[28:31], 0
    s_add_u32 m0, s63, 132096
    s_mov_b32 s35, 397312
    buffer_load_dwordx4 v10, s[48:51], s35 offen lds
    v_exp_f32 v58, v58
    v_exp_f32 v59, v59
    v_exp_f32 v60, v60
    v_exp_f32 v61, v61
    v_exp_f32 v62, v62
    v_smfmac_f32_32x32x32_bf16 v[84:99], v[20:23], v[52:59], v5
    s_mov_b64 exec, s[40:41]
    ds_read_b128 v[20:23], v4 offset:1024
    s_mov_b64 exec, -1
    v_exp_f32 v63, v63
    v_exp_f32 v64, v64
    v_exp_f32 v65, v65
    v_exp_f32 v66, v66
    v_exp_f32 v67, v67
    v_exp_f32 v36, v36
    v_exp_f32 v37, v37
    v_exp_f32 v38, v38
    v_smfmac_f32_32x32x32_bf16 v[84:99], v[24:27], v[60:67], v5
    s_mov_b64 exec, s[40:41]
    ds_read_b128 v[24:27], v4 offset:1280
    s_mov_b64 exec, -1
    v_exp_f32 v39, v39
    v_exp_f32 v40, v40
    v_exp_f32 v41, v41
    v_mfma_f32_32x32x16_bf16 v[52:67], v[12:15], v[32:35], 0
    s_waitcnt lgkmcnt(1)
    v_exp_f32 v42, v42
    v_exp_f32 v43, v43
    v_exp_f32 v44, v44
    v_exp_f32 v45, v45
    v_exp_f32 v46, v46
    v_smfmac_f32_32x32x32_bf16 v[68:83], v[20:23], v[36:43], v5
    s_waitcnt lgkmcnt(0)
    ds_read_b128 v[12:15], v4 offset:4096
    v_exp_f32 v47, v47
    v_exp_f32 v48, v48
    v_exp_f32 v49, v49
    v_exp_f32 v50, v50
    v_exp_f32 v51, v51
    v_exp_f32 v52, v52
    v_exp_f32 v53, v53
    v_exp_f32 v54, v54
    v_smfmac_f32_32x32x32_bf16 v[68:83], v[24:27], v[44:51], v5
    s_setprio 0
    s_add_u32 m0, s63, 2048
    s_mov_b32 s35, 139264
    buffer_load_dwordx4 v10, s[48:51], s35 offen lds
    v_exp_f32 v55, v55
    v_exp_f32 v56, v56
    v_exp_f32 v57, v57
    v_mfma_f32_32x32x16_bf16 v[36:51], v[16:19], v[28:31], 0
    s_add_u32 m0, s63, 133120
    s_mov_b32 s35, 401408
    buffer_load_dwordx4 v10, s[48:51], s35 offen lds
    v_exp_f32 v58, v58
    v_exp_f32 v59, v59
    v_exp_f32 v60, v60
    v_exp_f32 v61, v61
    v_exp_f32 v62, v62
    v_smfmac_f32_32x32x32_bf16 v[84:99], v[20:23], v[52:59], v5
    s_mov_b64 exec, s[40:41]
    ds_read_b128 v[20:23], v4 offset:3072
    s_mov_b64 exec, -1
    v_exp_f32 v63, v63
    v_exp_f32 v64, v64
    v_exp_f32 v65, v65
    v_exp_f32 v66, v66
    v_exp_f32 v67, v67
    v_exp_f32 v36, v36
    v_exp_f32 v37, v37
    v_exp_f32 v38, v38
    v_smfmac_f32_32x32x32_bf16 v[84:99], v[24:27], v[60:67], v5
    s_mov_b64 exec, s[40:41]
    ds_read_b128 v[24:27], v4 offset:3328
    s_mov_b64 exec, -1
    v_exp_f32 v39, v39
    v_exp_f32 v40, v40
    v_exp_f32 v41, v41
    v_mfma_f32_32x32x16_bf16 v[52:67], v[16:19], v[32:35], 0
    s_waitcnt lgkmcnt(1)
    v_exp_f32 v42, v42
    v_exp_f32 v43, v43
    v_exp_f32 v44, v44
    v_exp_f32 v45, v45
    v_exp_f32 v46, v46
    v_smfmac_f32_32x32x32_bf16 v[68:83], v[20:23], v[36:43], v5
    s_waitcnt lgkmcnt(0)
    ds_read_b128 v[16:19], v4 offset:6144
    v_exp_f32 v47, v47
    v_exp_f32 v48, v48
    v_exp_f32 v49, v49
    v_exp_f32 v50, v50
    v_exp_f32 v51, v51
    v_exp_f32 v52, v52
    v_exp_f32 v53, v53
    v_exp_f32 v54, v54
    v_smfmac_f32_32x32x32_bf16 v[68:83], v[24:27], v[44:51], v5
    s_add_u32 m0, s63, 3072
    s_mov_b32 s35, 143360
    buffer_load_dwordx4 v10, s[48:51], s35 offen lds
    v_exp_f32 v55, v55
    v_exp_f32 v56, v56
    v_exp_f32 v57, v57
    v_mfma_f32_32x32x16_bf16 v[36:51], v[12:15], v[28:31], 0
    s_add_u32 m0, s63, 134144
    s_mov_b32 s35, 405504
    buffer_load_dwordx4 v10, s[48:51], s35 offen lds
    v_exp_f32 v58, v58
    v_exp_f32 v59, v59
    v_exp_f32 v60, v60
    v_exp_f32 v61, v61
    v_exp_f32 v62, v62
    v_smfmac_f32_32x32x32_bf16 v[84:99], v[20:23], v[52:59], v5
    s_mov_b64 exec, s[40:41]
    ds_read_b128 v[20:23], v4 offset:5120
    s_mov_b64 exec, -1
    v_exp_f32 v63, v63
    v_exp_f32 v64, v64
    v_exp_f32 v65, v65
    v_exp_f32 v66, v66
    v_exp_f32 v67, v67
    s_waitcnt vmcnt(8)
    s_setprio 3
    s_barrier
    v_exp_f32 v36, v36
    v_exp_f32 v37, v37
    v_exp_f32 v38, v38
    v_smfmac_f32_32x32x32_bf16 v[84:99], v[24:27], v[60:67], v5
    s_mov_b64 exec, s[40:41]
    ds_read_b128 v[24:27], v4 offset:5376
    s_mov_b64 exec, -1
    v_exp_f32 v39, v39
    v_exp_f32 v40, v40
    v_exp_f32 v41, v41
    v_mfma_f32_32x32x16_bf16 v[52:67], v[12:15], v[32:35], 0
    s_waitcnt lgkmcnt(1)
    v_exp_f32 v42, v42
    v_exp_f32 v43, v43
    v_exp_f32 v44, v44
    v_exp_f32 v45, v45
    v_exp_f32 v46, v46
    v_smfmac_f32_32x32x32_bf16 v[68:83], v[20:23], v[36:43], v5
    s_waitcnt lgkmcnt(0)
    ds_read_b128 v[12:15], v4 offset:32768
    v_exp_f32 v47, v47
    v_exp_f32 v48, v48
    v_exp_f32 v49, v49
    v_exp_f32 v50, v50
    v_exp_f32 v51, v51
    v_exp_f32 v52, v52
    v_exp_f32 v53, v53
    v_exp_f32 v54, v54
    v_smfmac_f32_32x32x32_bf16 v[68:83], v[24:27], v[44:51], v5
    s_add_u32 m0, s63, 32768
    s_mov_b32 s35, 262144
    buffer_load_dwordx4 v10, s[48:51], s35 offen lds
    v_exp_f32 v55, v55
    v_exp_f32 v56, v56
    v_exp_f32 v57, v57
    v_mfma_f32_32x32x16_bf16 v[36:51], v[16:19], v[28:31], 0
    v_exp_f32 v58, v58
    v_exp_f32 v59, v59
    v_exp_f32 v60, v60
    v_exp_f32 v61, v61
    v_exp_f32 v62, v62
    v_smfmac_f32_32x32x32_bf16 v[84:99], v[20:23], v[52:59], v5
    s_mov_b64 exec, s[40:41]
    ds_read_b128 v[20:23], v4 offset:7168
    s_mov_b64 exec, -1
    v_exp_f32 v63, v63
    v_exp_f32 v64, v64
    v_exp_f32 v65, v65
    v_exp_f32 v66, v66
    v_exp_f32 v67, v67
    v_exp_f32 v36, v36
    v_exp_f32 v37, v37
    v_exp_f32 v38, v38
    v_smfmac_f32_32x32x32_bf16 v[84:99], v[24:27], v[60:67], v5
    s_mov_b64 exec, s[40:41]
    ds_read_b128 v[24:27], v4 offset:7424
    s_mov_b64 exec, -1
    v_exp_f32 v39, v39
    v_exp_f32 v40, v40
    v_exp_f32 v41, v41
    v_mfma_f32_32x32x16_bf16 v[52:67], v[16:19], v[32:35], 0
    s_waitcnt lgkmcnt(1)
    v_exp_f32 v42, v42
    v_exp_f32 v43, v43
    v_exp_f32 v44, v44
    v_exp_f32 v45, v45
    v_exp_f32 v46, v46
    v_smfmac_f32_32x32x32_bf16 v[68:83], v[20:23], v[36:43], v5
    s_waitcnt lgkmcnt(0)
    ds_read_b128 v[16:19], v4 offset:34816
    v_exp_f32 v47, v47
    v_exp_f32 v48, v48
    v_exp_f32 v49, v49
    v_exp_f32 v50, v50
    v_exp_f32 v51, v51
    v_exp_f32 v52, v52
    v_exp_f32 v53, v53
    v_exp_f32 v54, v54
    v_smfmac_f32_32x32x32_bf16 v[68:83], v[24:27], v[44:51], v5
    s_add_u32 m0, s63, 33792
    s_mov_b32 s35, 266240
    buffer_load_dwordx4 v10, s[48:51], s35 offen lds
    v_exp_f32 v55, v55
    v_exp_f32 v56, v56
    v_exp_f32 v57, v57
    v_mfma_f32_32x32x16_bf16 v[36:51], v[12:15], v[28:31], 0
    v_exp_f32 v58, v58
    v_exp_f32 v59, v59
    v_exp_f32 v60, v60
    v_exp_f32 v61, v61
    v_exp_f32 v62, v62
    v_smfmac_f32_32x32x32_bf16 v[84:99], v[20:23], v[52:59], v5
    s_mov_b64 exec, s[40:41]
    ds_read_b128 v[20:23], v4 offset:33792
    s_mov_b64 exec, -1
    v_exp_f32 v63, v63
    v_exp_f32 v64, v64
    v_exp_f32 v65, v65
    v_exp_f32 v66, v66
    v_exp_f32 v67, v67
    v_exp_f32 v36, v36
    v_exp_f32 v37, v37
    v_exp_f32 v38, v38
    v_smfmac_f32_32x32x32_bf16 v[84:99], v[24:27], v[60:67], v5
    s_mov_b64 exec, s[40:41]
    ds_read_b128 v[24:27], v4 offset:34048
    s_mov_b64 exec, -1
    v_exp_f32 v39, v39
    v_exp_f32 v40, v40
    v_exp_f32 v41, v41
    v_mfma_f32_32x32x16_bf16 v[52:67], v[12:15], v[32:35], 0
    s_waitcnt lgkmcnt(1)
    v_exp_f32 v42, v42
    v_exp_f32 v43, v43
    v_exp_f32 v44, v44
    v_exp_f32 v45, v45
    v_exp_f32 v46, v46
    v_smfmac_f32_32x32x32_bf16 v[68:83], v[20:23], v[36:43], v5
    s_waitcnt lgkmcnt(0)
    ds_read_b128 v[12:15], v4 offset:36864
    v_exp_f32 v47, v47
    v_exp_f32 v48, v48
    v_exp_f32 v49, v49
    v_exp_f32 v50, v50
    v_exp_f32 v51, v51
    v_exp_f32 v52, v52
    v_exp_f32 v53, v53
    v_exp_f32 v54, v54
    v_smfmac_f32_32x32x32_bf16 v[68:83], v[24:27], v[44:51], v5
    s_setprio 2
    s_add_u32 m0, s63, 34816
    s_mov_b32 s35, 270336
    buffer_load_dwordx4 v10, s[48:51], s35 offen lds
    v_exp_f32 v55, v55
    v_exp_f32 v56, v56
    v_exp_f32 v57, v57
    v_mfma_f32_32x32x16_bf16 v[36:51], v[16:19], v[28:31], 0
    v_exp_f32 v58, v58
    v_exp_f32 v59, v59
    v_exp_f32 v60, v60
    v_exp_f32 v61, v61
    v_exp_f32 v62, v62
    v_smfmac_f32_32x32x32_bf16 v[84:99], v[20:23], v[52:59], v5
    s_mov_b64 exec, s[40:41]
    ds_read_b128 v[20:23], v4 offset:35840
    s_mov_b64 exec, -1
    v_exp_f32 v63, v63
    v_exp_f32 v64, v64
    v_exp_f32 v65, v65
    v_exp_f32 v66, v66
    v_exp_f32 v67, v67
    v_exp_f32 v36, v36
    v_exp_f32 v37, v37
    v_exp_f32 v38, v38
    v_smfmac_f32_32x32x32_bf16 v[84:99], v[24:27], v[60:67], v5
    s_mov_b64 exec, s[40:41]
    ds_read_b128 v[24:27], v4 offset:36096
    s_mov_b64 exec, -1
    v_exp_f32 v39, v39
    v_exp_f32 v40, v40
    v_exp_f32 v41, v41
    v_mfma_f32_32x32x16_bf16 v[52:67], v[16:19], v[32:35], 0
    s_waitcnt lgkmcnt(1)
    v_exp_f32 v42, v42
    v_exp_f32 v43, v43
    v_exp_f32 v44, v44
    v_exp_f32 v45, v45
    v_exp_f32 v46, v46
    v_smfmac_f32_32x32x32_bf16 v[68:83], v[20:23], v[36:43], v5
    s_waitcnt lgkmcnt(0)
    ds_read_b128 v[16:19], v4 offset:38912
    v_exp_f32 v47, v47
    v_exp_f32 v48, v48
    v_exp_f32 v49, v49
    v_exp_f32 v50, v50
    v_exp_f32 v51, v51
    v_exp_f32 v52, v52
    v_exp_f32 v53, v53
    v_exp_f32 v54, v54
    v_smfmac_f32_32x32x32_bf16 v[68:83], v[24:27], v[44:51], v5
    s_add_u32 m0, s63, 35840
    s_mov_b32 s35, 274432
    buffer_load_dwordx4 v10, s[48:51], s35 offen lds
    v_exp_f32 v55, v55
    v_exp_f32 v56, v56
    v_exp_f32 v57, v57
    v_mfma_f32_32x32x16_bf16 v[36:51], v[12:15], v[28:31], 0
    v_exp_f32 v58, v58
    v_exp_f32 v59, v59
    v_exp_f32 v60, v60
    v_exp_f32 v61, v61
    v_exp_f32 v62, v62
    v_smfmac_f32_32x32x32_bf16 v[84:99], v[20:23], v[52:59], v5
    s_mov_b64 exec, s[40:41]
    ds_read_b128 v[20:23], v4 offset:37888
    s_mov_b64 exec, -1
    v_exp_f32 v63, v63
    v_exp_f32 v64, v64
    v_exp_f32 v65, v65
    v_exp_f32 v66, v66
    v_exp_f32 v67, v67
    v_exp_f32 v36, v36
    v_exp_f32 v37, v37
    v_exp_f32 v38, v38
    v_smfmac_f32_32x32x32_bf16 v[84:99], v[24:27], v[60:67], v5
    s_mov_b64 exec, s[40:41]
    ds_read_b128 v[24:27], v4 offset:38144
    s_mov_b64 exec, -1
    v_exp_f32 v39, v39
    v_exp_f32 v40, v40
    v_exp_f32 v41, v41
    v_mfma_f32_32x32x16_bf16 v[52:67], v[12:15], v[32:35], 0
    s_waitcnt lgkmcnt(1)
    v_exp_f32 v42, v42
    v_exp_f32 v43, v43
    v_exp_f32 v44, v44
    v_exp_f32 v45, v45
    v_exp_f32 v46, v46
    v_smfmac_f32_32x32x32_bf16 v[68:83], v[20:23], v[36:43], v5
    s_waitcnt lgkmcnt(0)
    v_exp_f32 v47, v47
    v_exp_f32 v48, v48
    v_exp_f32 v49, v49
    v_exp_f32 v50, v50
    v_exp_f32 v51, v51
    v_exp_f32 v52, v52
    v_exp_f32 v53, v53
    v_exp_f32 v54, v54
    v_smfmac_f32_32x32x32_bf16 v[68:83], v[24:27], v[44:51], v5
    s_setprio 1
    v_exp_f32 v55, v55
    v_exp_f32 v56, v56
    v_exp_f32 v57, v57
    v_mfma_f32_32x32x16_bf16 v[36:51], v[16:19], v[28:31], 0
    v_exp_f32 v58, v58
    v_exp_f32 v59, v59
    v_exp_f32 v60, v60
    v_exp_f32 v61, v61
    v_exp_f32 v62, v62
    v_smfmac_f32_32x32x32_bf16 v[84:99], v[20:23], v[52:59], v5
    s_mov_b64 exec, s[40:41]
    ds_read_b128 v[20:23], v4 offset:39936
    s_mov_b64 exec, -1
    v_exp_f32 v63, v63
    v_exp_f32 v64, v64
    v_exp_f32 v65, v65
    v_exp_f32 v66, v66
    v_exp_f32 v67, v67
    v_exp_f32 v36, v36
    v_exp_f32 v37, v37
    v_exp_f32 v38, v38
    v_smfmac_f32_32x32x32_bf16 v[84:99], v[24:27], v[60:67], v5
    s_mov_b64 exec, s[40:41]
    ds_read_b128 v[24:27], v4 offset:40192
    s_mov_b64 exec, -1
    v_exp_f32 v39, v39
    v_exp_f32 v40, v40
    v_exp_f32 v41, v41
    v_mfma_f32_32x32x16_bf16 v[52:67], v[16:19], v[32:35], 0
    s_waitcnt lgkmcnt(1)
    v_exp_f32 v42, v42
    v_exp_f32 v43, v43
    v_exp_f32 v44, v44
    v_exp_f32 v45, v45
    v_exp_f32 v46, v46
    v_smfmac_f32_32x32x32_bf16 v[68:83], v[20:23], v[36:43], v5
    s_waitcnt lgkmcnt(0)
    v_exp_f32 v47, v47
    v_exp_f32 v48, v48
    v_exp_f32 v49, v49
    v_exp_f32 v50, v50
    v_exp_f32 v51, v51
    v_exp_f32 v52, v52
    v_exp_f32 v53, v53
    v_exp_f32 v54, v54
    v_smfmac_f32_32x32x32_bf16 v[68:83], v[24:27], v[44:51], v5
    s_setprio 0
    v_exp_f32 v55, v55
    v_exp_f32 v56, v56
    v_exp_f32 v57, v57
    v_exp_f32 v58, v58
    v_exp_f32 v59, v59
    v_exp_f32 v60, v60
    v_exp_f32 v61, v61
    v_exp_f32 v62, v62
    v_smfmac_f32_32x32x32_bf16 v[84:99], v[20:23], v[52:59], v5
    v_exp_f32 v63, v63
    v_exp_f32 v64, v64
    v_exp_f32 v65, v65
    v_exp_f32 v66, v66
    v_exp_f32 v67, v67
    s_nop 2
    v_smfmac_f32_32x32x32_bf16 v[84:99], v[24:27], v[60:67], v5
    s_setprio 0
    s_mov_b32 s64, 0
L_check:
    s_add_u32 s37, s81, 32768
    v_rcp_f32 v6, v76
    s_mov_b32 s34, 0x2f800000
    s_mov_b32 s35, 0x5f800000
    s_movk_i32 s36, 0x207
    s_cmp_eq_u64 s[66:67], 0
    v_pk_mul_f32 v[68:69], v[68:69], v[6:7] op_sel_hi:[1,0]
    v_pk_mul_f32 v[70:71], v[70:71], v[6:7] op_sel_hi:[1,0]
    v_pk_mul_f32 v[72:73], v[72:73], v[6:7] op_sel_hi:[1,0]
    v_pk_mul_f32 v[74:75], v[74:75], v[6:7] op_sel_hi:[1,0]
    v_cvt_pk_bf16_f32 v36, v68, v69
    v_cvt_pk_bf16_f32 v37, v70, v71
    v_cvt_pk_bf16_f32 v38, v72, v73
    v_cvt_pk_bf16_f32 v39, v74, v75
    s_cbranch_scc1 L_ost0_loc
    buffer_store_dwordx4 v[36:39], v2, s[24:27], s81 offen sc1
    s_branch L_ost0_done
L_ost0_loc:
    buffer_store_dwordx4 v[36:39], v2, s[24:27], s81 offen
L_ost0_done:
    v_rcp_f32 v6, v92
    s_nop 0
    v_pk_mul_f32 v[84:85], v[84:85], v[6:7] op_sel_hi:[1,0]
    v_pk_mul_f32 v[86:87], v[86:87], v[6:7] op_sel_hi:[1,0]
    v_pk_mul_f32 v[88:89], v[88:89], v[6:7] op_sel_hi:[1,0]
    v_pk_mul_f32 v[90:91], v[90:91], v[6:7] op_sel_hi:[1,0]
    v_cvt_pk_bf16_f32 v52, v84, v85
    v_cvt_pk_bf16_f32 v53, v86, v87
    v_cvt_pk_bf16_f32 v54, v88, v89
    v_cvt_pk_bf16_f32 v55, v90, v91
    s_cbranch_scc1 L_ost1_loc
    buffer_store_dwordx4 v[52:55], v2, s[24:27], s37 offen sc1
    s_branch L_ost1_done
L_ost1_loc:
    buffer_store_dwordx4 v[52:55], v2, s[24:27], s37 offen
L_ost1_done:
    s_mov_b64 s[76:77], 0
    v_pk_add_f32 v[6:7], v[68:69], v[70:71]
    v_pk_add_f32 v[8:9], v[72:73], v[74:75]
    v_cmp_nge_f32 vcc, s35, v76
    s_or_b64 s[76:77], s[76:77], vcc
    v_pk_add_f32 v[6:7], v[6:7], v[8:9]
    v_cmp_nle_f32 vcc, s34, v76
    s_or_b64 s[76:77], s[76:77], vcc
    v_add_f32 v6, v6, v7
    v_cmp_class_f32 vcc, v6, s36
    s_or_b64 s[76:77], s[76:77], vcc
    v_pk_add_f32 v[6:7], v[84:85], v[86:87]
    v_pk_add_f32 v[8:9], v[88:89], v[90:91]
    v_cmp_nge_f32 vcc, s35, v92
    s_or_b64 s[76:77], s[76:77], vcc
    v_pk_add_f32 v[6:7], v[6:7], v[8:9]
    v_cmp_nle_f32 vcc, s34, v92
    s_or_b64 s[76:77], s[76:77], vcc
    v_add_f32 v6, v6, v7
    v_cmp_class_f32 vcc, v6, s36
    s_or_b64 s[76:77], s[76:77], vcc
    s_cbranch_scc1 L_fallback
L_norm:
    s_cmp_lg_u32 s28, 0
    s_waitcnt vmcnt(0)
    s_barrier
    s_cbranch_scc1 L_noflag
    s_mov_b64 exec, 1
    s_cmp_eq_u64 s[66:67], 0
    s_cbranch_scc1 L_oflag_loc
    buffer_store_dwordx2 v[240:241], v238, s[24:27], s82 offen sc1
    s_branch L_oflag_done
L_oflag_loc:
    buffer_store_dwordx2 v[240:241], v238, s[24:27], s82 offen
L_oflag_done:
    s_mov_b64 exec, -1
L_noflag:
    ds_read_b64_tr_b16 v[132:133], v11 offset:0
    ds_read_b64_tr_b16 v[134:135], v11 offset:2048
    ds_read_b64_tr_b16 v[136:137], v11 offset:4096
    ds_read_b64_tr_b16 v[138:139], v11 offset:6144
    ds_read_b64_tr_b16 v[140:141], v11 offset:8192
    ds_read_b64_tr_b16 v[142:143], v11 offset:10240
    ds_read_b64_tr_b16 v[144:145], v11 offset:12288
    ds_read_b64_tr_b16 v[146:147], v11 offset:14336
    ds_read_b64_tr_b16 v[148:149], v11 offset:16384
    ds_read_b64_tr_b16 v[150:151], v11 offset:18432
    ds_read_b64_tr_b16 v[152:153], v11 offset:20480
    ds_read_b64_tr_b16 v[154:155], v11 offset:22528
    ds_read_b64_tr_b16 v[156:157], v11 offset:24576
    ds_read_b64_tr_b16 v[158:159], v11 offset:26624
    ds_read_b64_tr_b16 v[160:161], v11 offset:28672
    ds_read_b64_tr_b16 v[162:163], v11 offset:30720
    buffer_load_dwordx2 v[232:233], v238, s[24:27], s83 offen sc1
    ds_read_b64_tr_b16 v[164:165], v11 offset:32768
    ds_read_b64_tr_b16 v[166:167], v11 offset:34816
    ds_read_b64_tr_b16 v[168:169], v11 offset:36864
    ds_read_b64_tr_b16 v[170:171], v11 offset:38912
    ds_read_b64_tr_b16 v[172:173], v11 offset:40960
    ds_read_b64_tr_b16 v[174:175], v11 offset:43008
    ds_read_b64_tr_b16 v[176:177], v11 offset:45056
    ds_read_b64_tr_b16 v[178:179], v11 offset:47104
    ds_read_b64_tr_b16 v[180:181], v11 offset:49152
    ds_read_b64_tr_b16 v[182:183], v11 offset:51200
    ds_read_b64_tr_b16 v[184:185], v11 offset:53248
    ds_read_b64_tr_b16 v[186:187], v11 offset:55296
    ds_read_b64_tr_b16 v[188:189], v11 offset:57344
    ds_read_b64_tr_b16 v[190:191], v11 offset:59392
    ds_read_b64_tr_b16 v[192:193], v11 offset:61440
    ds_read_b64_tr_b16 v[194:195], v11 offset:63488
    s_waitcnt vmcnt(0)
    s_mov_b32 s38, 0
L_pollo:
    v_cmp_ne_u64 vcc, s[60:61], v[232:233]
    s_cbranch_vccz L_pollo_ok
    s_add_u32 s38, s38, 1
    s_cmp_ge_u32 s38, 2097152
    s_cbranch_scc1 L_pollo_ok
    buffer_load_dwordx2 v[232:233], v238, s[24:27], s83 offen sc1
    s_waitcnt vmcnt(0)
    s_branch L_pollo
L_pollo_ok:
    s_add_u32 m0, s63, 65536
    s_add_u32 s35, s84, 0
    buffer_load_dwordx4 v2, s[24:27], s35 offen offset:0 sc1 lds
    buffer_load_dwordx4 v2, s[24:27], s35 offen offset:1024 sc1 lds
    buffer_load_dwordx4 v2, s[24:27], s35 offen offset:2048 sc1 lds
    buffer_load_dwordx4 v2, s[24:27], s35 offen offset:3072 sc1 lds
    s_add_u32 m0, s63, 98304
    s_add_u32 s35, s84, 32768
    buffer_load_dwordx4 v2, s[24:27], s35 offen offset:0 sc1 lds
    buffer_load_dwordx4 v2, s[24:27], s35 offen offset:1024 sc1 lds
    buffer_load_dwordx4 v2, s[24:27], s35 offen offset:2048 sc1 lds
    buffer_load_dwordx4 v2, s[24:27], s35 offen offset:3072 sc1 lds
    ds_read_b64_tr_b16 v[196:197], v231 offset:0
    ds_read_b64_tr_b16 v[198:199], v231 offset:2048
    ds_read_b64_tr_b16 v[200:201], v231 offset:4096
    ds_read_b64_tr_b16 v[202:203], v231 offset:6144
    ds_read_b64_tr_b16 v[204:205], v231 offset:8192
    ds_read_b64_tr_b16 v[206:207], v231 offset:10240
    ds_read_b64_tr_b16 v[208:209], v231 offset:12288
    ds_read_b64_tr_b16 v[210:211], v231 offset:14336
    ds_read_b64_tr_b16 v[212:213], v231 offset:16384
    ds_read_b64_tr_b16 v[214:215], v231 offset:18432
    ds_read_b64_tr_b16 v[216:217], v231 offset:20480
    ds_read_b64_tr_b16 v[218:219], v231 offset:22528
    ds_read_b64_tr_b16 v[220:221], v231 offset:24576
    ds_read_b64_tr_b16 v[222:223], v231 offset:26624
    ds_read_b64_tr_b16 v[224:225], v231 offset:28672
    ds_read_b64_tr_b16 v[226:227], v231 offset:30720
    s_cmp_lg_u32 s33, 0
    s_waitcnt vmcnt(4) lgkmcnt(0)
    s_barrier
    s_cbranch_scc1 L_second
    ds_read_b128 v[68:71], v229 offset:0
    ds_read_b128 v[72:75], v229 offset:1024
    ds_read_b128 v[76:79], v229 offset:2048
    ds_read_b128 v[80:83], v229 offset:3072
    ds_read_b128 v[84:87], v229 offset:4096
    ds_read_b128 v[88:91], v229 offset:5120
    ds_read_b128 v[92:95], v229 offset:6144
    ds_read_b128 v[96:99], v229 offset:7168
    s_waitcnt lgkmcnt(7)
    v_mfma_f32_32x32x16_bf16 v[36:51], v[100:103], v[68:71], 0
    ds_read_b128 v[68:71], v229 offset:8192
    s_waitcnt lgkmcnt(7)
    v_mfma_f32_32x32x16_bf16 v[36:51], v[104:107], v[72:75], v[36:51]
    ds_read_b128 v[72:75], v229 offset:9216
    s_waitcnt lgkmcnt(7)
    v_mfma_f32_32x32x16_bf16 v[36:51], v[108:111], v[76:79], v[36:51]
    ds_read_b128 v[76:79], v229 offset:10240
    s_waitcnt lgkmcnt(7)
    v_mfma_f32_32x32x16_bf16 v[36:51], v[112:115], v[80:83], v[36:51]
    ds_read_b128 v[80:83], v229 offset:11264
    s_waitcnt lgkmcnt(7)
    v_mfma_f32_32x32x16_bf16 v[36:51], v[116:119], v[84:87], v[36:51]
    ds_read_b128 v[84:87], v229 offset:12288
    s_waitcnt lgkmcnt(7)
    v_mfma_f32_32x32x16_bf16 v[36:51], v[120:123], v[88:91], v[36:51]
    s_waitcnt vmcnt(0)
    s_barrier
L_rest:
    s_lshr_b32 s34, s2, 3
    s_lshl_b32 s34, s34, 3
    s_or_b32 s34, s34, s28
    s_cmp_lg_u32 s34, 120
    s_cbranch_scc1 L_wb0
    buffer_wbl2 sc1
L_wb0:
    ds_read_b128 v[88:91], v229 offset:13312
    s_waitcnt lgkmcnt(7)
    v_mfma_f32_32x32x16_bf16 v[36:51], v[124:127], v[92:95], v[36:51]
    ds_read_b128 v[92:95], v229 offset:14336
    s_waitcnt lgkmcnt(7)
    v_mfma_f32_32x32x16_bf16 v[36:51], v[128:131], v[96:99], v[36:51]
    ds_read_b128 v[96:99], v229 offset:15360
    s_waitcnt lgkmcnt(7)
    v_mfma_f32_32x32x16_bf16 v[36:51], v[132:135], v[68:71], v[36:51]
    ds_read_b128 v[68:71], v229 offset:16384
    s_waitcnt lgkmcnt(7)
    v_mfma_f32_32x32x16_bf16 v[36:51], v[136:139], v[72:75], v[36:51]
    ds_read_b128 v[72:75], v229 offset:17408
    s_waitcnt lgkmcnt(7)
    v_mfma_f32_32x32x16_bf16 v[36:51], v[140:143], v[76:79], v[36:51]
    ds_read_b128 v[76:79], v229 offset:18432
    s_waitcnt lgkmcnt(7)
    v_mfma_f32_32x32x16_bf16 v[36:51], v[144:147], v[80:83], v[36:51]
    ds_read_b128 v[80:83], v229 offset:19456
    s_waitcnt lgkmcnt(7)
    v_mfma_f32_32x32x16_bf16 v[36:51], v[148:151], v[84:87], v[36:51]
    ds_read_b128 v[84:87], v229 offset:20480
    s_waitcnt lgkmcnt(7)
    v_mfma_f32_32x32x16_bf16 v[36:51], v[152:155], v[88:91], v[36:51]
    ds_read_b128 v[88:91], v229 offset:21504
    s_waitcnt lgkmcnt(7)
    v_mfma_f32_32x32x16_bf16 v[36:51], v[156:159], v[92:95], v[36:51]
    ds_read_b128 v[92:95], v229 offset:22528
    s_waitcnt lgkmcnt(7)
    v_mfma_f32_32x32x16_bf16 v[36:51], v[160:163], v[96:99], v[36:51]
    ds_read_b128 v[96:99], v229 offset:23552
    s_waitcnt lgkmcnt(7)
    v_mfma_f32_32x32x16_bf16 v[36:51], v[164:167], v[68:71], v[36:51]
    ds_read_b128 v[68:71], v229 offset:24576
    s_waitcnt lgkmcnt(7)
    v_mfma_f32_32x32x16_bf16 v[36:51], v[168:171], v[72:75], v[36:51]
    ds_read_b128 v[72:75], v229 offset:25600
    s_waitcnt lgkmcnt(7)
    v_mfma_f32_32x32x16_bf16 v[36:51], v[172:175], v[76:79], v[36:51]
    ds_read_b128 v[76:79], v229 offset:26624
    s_waitcnt lgkmcnt(7)
    v_mfma_f32_32x32x16_bf16 v[36:51], v[176:179], v[80:83], v[36:51]
    ds_read_b128 v[80:83], v229 offset:27648
    s_waitcnt lgkmcnt(7)
    v_mfma_f32_32x32x16_bf16 v[36:51], v[180:183], v[84:87], v[36:51]
    ds_read_b128 v[84:87], v229 offset:28672
    s_waitcnt lgkmcnt(7)
    v_mfma_f32_32x32x16_bf16 v[36:51], v[184:187], v[88:91], v[36:51]
    ds_read_b128 v[88:91], v229 offset:29696
    s_waitcnt lgkmcnt(7)
    v_mfma_f32_32x32x16_bf16 v[36:51], v[188:191], v[92:95], v[36:51]
    ds_read_b128 v[92:95], v229 offset:30720
    s_waitcnt lgkmcnt(7)
    v_mfma_f32_32x32x16_bf16 v[36:51], v[192:195], v[96:99], v[36:51]
    ds_read_b128 v[96:99], v229 offset:31744
    s_waitcnt lgkmcnt(7)
    v_mfma_f32_32x32x16_bf16 v[36:51], v[196:199], v[68:71], v[36:51]
    s_waitcnt lgkmcnt(6)
    v_mfma_f32_32x32x16_bf16 v[36:51], v[200:203], v[72:75], v[36:51]
    s_waitcnt lgkmcnt(5)
    v_mfma_f32_32x32x16_bf16 v[36:51], v[204:207], v[76:79], v[36:51]
    s_waitcnt lgkmcnt(4)
    v_mfma_f32_32x32x16_bf16 v[36:51], v[208:211], v[80:83], v[36:51]
    s_waitcnt lgkmcnt(3)
    v_mfma_f32_32x32x16_bf16 v[36:51], v[212:215], v[84:87], v[36:51]
    s_waitcnt lgkmcnt(2)
    v_mfma_f32_32x32x16_bf16 v[36:51], v[216:219], v[88:91], v[36:51]
    s_waitcnt lgkmcnt(1)
    v_mfma_f32_32x32x16_bf16 v[36:51], v[220:223], v[92:95], v[36:51]
    s_waitcnt lgkmcnt(0)
    v_mfma_f32_32x32x16_bf16 v[36:51], v[224:227], v[96:99], v[36:51]
    s_nop 11
    v_cvt_pk_bf16_f32 v52, v36, v37
    v_cvt_pk_bf16_f32 v53, v38, v39
    v_cvt_pk_bf16_f32 v54, v40, v41
    v_cvt_pk_bf16_f32 v55, v42, v43
    v_cvt_pk_bf16_f32 v56, v44, v45
    v_cvt_pk_bf16_f32 v57, v46, v47
    v_cvt_pk_bf16_f32 v58, v48, v49
    v_cvt_pk_bf16_f32 v59, v50, v51
    s_nop 1
    v_permlane32_swap_b32 v52, v54
    v_permlane32_swap_b32 v53, v55
    v_permlane32_swap_b32 v56, v58
    v_permlane32_swap_b32 v57, v59
    buffer_store_dwordx4 v[52:55], v228, s[52:55], s85 offen
    buffer_store_dwordx4 v[56:59], v228, s[52:55], s85 offen offset:32
L_end:
    s_endpgm
L_second:
    s_waitcnt vmcnt(0)
    s_barrier
    ds_read_b128 v[68:71], v229 offset:0
    ds_read_b128 v[72:75], v229 offset:1024
    ds_read_b128 v[76:79], v229 offset:2048
    ds_read_b128 v[80:83], v229 offset:3072
    ds_read_b128 v[84:87], v229 offset:4096
    ds_read_b128 v[88:91], v229 offset:5120
    ds_read_b128 v[92:95], v229 offset:6144
    ds_read_b128 v[96:99], v229 offset:7168
    s_waitcnt lgkmcnt(7)
    v_mfma_f32_32x32x16_bf16 v[36:51], v[100:103], v[68:71], 0
    ds_read_b128 v[68:71], v229 offset:8192
    s_waitcnt lgkmcnt(7)
    v_mfma_f32_32x32x16_bf16 v[36:51], v[104:107], v[72:75], v[36:51]
    ds_read_b128 v[72:75], v229 offset:9216
    s_waitcnt lgkmcnt(7)
    v_mfma_f32_32x32x16_bf16 v[36:51], v[108:111], v[76:79], v[36:51]
    ds_read_b128 v[76:79], v229 offset:10240
    s_waitcnt lgkmcnt(7)
    v_mfma_f32_32x32x16_bf16 v[36:51], v[112:115], v[80:83], v[36:51]
    ds_read_b128 v[80:83], v229 offset:11264
    s_waitcnt lgkmcnt(7)
    v_mfma_f32_32x32x16_bf16 v[36:51], v[116:119], v[84:87], v[36:51]
    ds_read_b128 v[84:87], v229 offset:12288
    s_waitcnt lgkmcnt(7)
    v_mfma_f32_32x32x16_bf16 v[36:51], v[120:123], v[88:91], v[36:51]
    s_branch L_rest
L_fallback:
    s_cmp_lg_u32 s64, 0
    s_cbranch_scc1 L_norm
    s_mov_b32 s64, 1
    s_add_u32 s34, s65, s32
    s_lshl_b32 s34, s34, 17
    s_add_u32 s87, s34, 4194304
    v_mov_b32 v6, 0xff800000
    v_mov_b32 v7, 0xff800000
    s_mov_b32 s36, s87
    s_movk_i32 s37, 64
L_fb_max:
    buffer_load_dwordx4 v[12:15], v2, s[24:27], s36 offen sc1
    s_add_u32 s36, s36, 2048
    s_waitcnt vmcnt(0)
    v_mfma_f32_32x32x16_bf16 v[36:51], v[12:15], v[28:31], 0
    v_mfma_f32_32x32x16_bf16 v[52:67], v[12:15], v[32:35], 0
    s_nop 15
    v_max3_f32 v6, v6, v36, v37
    v_max3_f32 v6, v6, v38, v39
    v_max3_f32 v6, v6, v40, v41
    v_max3_f32 v6, v6, v42, v43
    v_max3_f32 v6, v6, v44, v45
    v_max3_f32 v6, v6, v46, v47
    v_max3_f32 v6, v6, v48, v49
    v_max3_f32 v6, v6, v50, v51
    v_max3_f32 v7, v7, v52, v53
    v_max3_f32 v7, v7, v54, v55
    v_max3_f32 v7, v7, v56, v57
    v_max3_f32 v7, v7, v58, v59
    v_max3_f32 v7, v7, v60, v61
    v_max3_f32 v7, v7, v62, v63
    v_max3_f32 v7, v7, v64, v65
    v_max3_f32 v7, v7, v66, v67
    s_sub_u32 s37, s37, 1
    s_cmp_lg_u32 s37, 0
    s_cbranch_scc1 L_fb_max
    v_mov_b32 v8, v6
    s_nop 1
    v_permlane32_swap_b32 v8, v6
    s_nop 1
    v_max_f32 v6, v8, v6
    v_mov_b32 v68, 0
    v_mov_b32 v69, 0
    v_mov_b32 v70, 0
    v_mov_b32 v71, 0
    v_mov_b32 v72, 0
    v_mov_b32 v73, 0
    v_mov_b32 v74, 0
    v_mov_b32 v75, 0
    v_mov_b32 v76, 0
    v_mov_b32 v77, 0
    v_mov_b32 v78, 0
    v_mov_b32 v79, 0
    v_mov_b32 v80, 0
    v_mov_b32 v81, 0
    v_mov_b32 v82, 0
    v_mov_b32 v83, 0
    v_mov_b32 v8, v7
    s_nop 1
    v_permlane32_swap_b32 v8, v7
    s_nop 1
    v_max_f32 v7, v8, v7
    v_mov_b32 v84, 0
    v_mov_b32 v85, 0
    v_mov_b32 v86, 0
    v_mov_b32 v87, 0
    v_mov_b32 v88, 0
    v_mov_b32 v89, 0
    v_mov_b32 v90, 0
    v_mov_b32 v91, 0
    v_mov_b32 v92, 0
    v_mov_b32 v93, 0
    v_mov_b32 v94, 0
    v_mov_b32 v95, 0
    v_mov_b32 v96, 0
    v_mov_b32 v97, 0
    v_mov_b32 v98, 0
    v_mov_b32 v99, 0
    s_mov_b32 s36, s87
    s_movk_i32 s37, 64
L_fb_pv:
    buffer_load_dwordx4 v[12:15], v2, s[24:27], s36 offen sc1
    s_mov_b64 exec, s[40:41]
    buffer_load_dwordx4 v[20:23], v2, s[24:27], s36 offen offset:1024 sc1
    buffer_load_dwordx4 v[24:27], v2, s[24:27], s36 offen offset:1280 sc1
    s_mov_b64 exec, -1
    s_add_u32 s36, s36, 2048
    s_waitcnt vmcnt(0)
    v_mfma_f32_32x32x16_bf16 v[36:51], v[12:15], v[28:31], 0
    v_mfma_f32_32x32x16_bf16 v[52:67], v[12:15], v[32:35], 0
    s_nop 15
    v_sub_f32 v36, v36, v6
    v_sub_f32 v37, v37, v6
    v_sub_f32 v38, v38, v6
    v_sub_f32 v39, v39, v6
    v_sub_f32 v40, v40, v6
    v_sub_f32 v41, v41, v6
    v_sub_f32 v42, v42, v6
    v_sub_f32 v43, v43, v6
    v_sub_f32 v44, v44, v6
    v_sub_f32 v45, v45, v6
    v_sub_f32 v46, v46, v6
    v_sub_f32 v47, v47, v6
    v_sub_f32 v48, v48, v6
    v_sub_f32 v49, v49, v6
    v_sub_f32 v50, v50, v6
    v_sub_f32 v51, v51, v6
    v_exp_f32 v36, v36
    v_exp_f32 v37, v37
    v_exp_f32 v38, v38
    v_exp_f32 v39, v39
    v_exp_f32 v40, v40
    v_exp_f32 v41, v41
    v_exp_f32 v42, v42
    v_exp_f32 v43, v43
    v_exp_f32 v44, v44
    v_exp_f32 v45, v45
    v_exp_f32 v46, v46
    v_exp_f32 v47, v47
    v_exp_f32 v48, v48
    v_exp_f32 v49, v49
    v_exp_f32 v50, v50
    v_exp_f32 v51, v51
    v_sub_f32 v52, v52, v7
    v_sub_f32 v53, v53, v7
    v_sub_f32 v54, v54, v7
    v_sub_f32 v55, v55, v7
    v_sub_f32 v56, v56, v7
    v_sub_f32 v57, v57, v7
    v_sub_f32 v58, v58, v7
    v_sub_f32 v59, v59, v7
    v_sub_f32 v60, v60, v7
    v_sub_f32 v61, v61, v7
    v_sub_f32 v62, v62, v7
    v_sub_f32 v63, v63, v7
    v_sub_f32 v64, v64, v7
    v_sub_f32 v65, v65, v7
    v_sub_f32 v66, v66, v7
    v_sub_f32 v67, v67, v7
    v_exp_f32 v52, v52
    v_exp_f32 v53, v53
    v_exp_f32 v54, v54
    v_exp_f32 v55, v55
    v_exp_f32 v56, v56
    v_exp_f32 v57, v57
    v_exp_f32 v58, v58
    v_exp_f32 v59, v59
    v_exp_f32 v60, v60
    v_exp_f32 v61, v61
    v_exp_f32 v62, v62
    v_exp_f32 v63, v63
    v_exp_f32 v64, v64
    v_exp_f32 v65, v65
    v_exp_f32 v66, v66
    v_exp_f32 v67, v67
    s_nop 2
    v_smfmac_f32_32x32x32_bf16 v[68:83], v[20:23], v[36:43], v5
    v_smfmac_f32_32x32x32_bf16 v[68:83], v[24:27], v[44:51], v5
    v_smfmac_f32_32x32x32_bf16 v[84:99], v[20:23], v[52:59], v5
    v_smfmac_f32_32x32x32_bf16 v[84:99], v[24:27], v[60:67], v5
    s_sub_u32 s37, s37, 1
    s_cmp_lg_u32 s37, 0
    s_cbranch_scc1 L_fb_pv
    s_nop 15
    s_branch L_check
L_tagpoll:
    s_add_u32 s38, s38, 1
    s_cmp_ge_u32 s38, 2097152
    s_cbranch_scc1 L_tagok
    buffer_load_dwordx2 v[232:233], v238, s[44:47], 0 offen sc1
    s_waitcnt vmcnt(0)
    v_readfirstlane_b32 s60, v232
    v_readfirstlane_b32 s61, v233
    s_branch L_tagwait
L_code_end:
.section .rodata,"a"
.p2align 6
.amdhsa_kernel concat_heads__softmax_full_mha__mha_block__prompt_kernel
  .amdhsa_next_free_vgpr 248
  .amdhsa_next_free_sgpr 102
  .amdhsa_accum_offset 248
  .amdhsa_group_segment_fixed_size 0
  .amdhsa_kernarg_size 72
  .amdhsa_user_sgpr_count 2
  .amdhsa_user_sgpr_kernarg_segment_ptr 1
  .amdhsa_system_sgpr_workgroup_id_x 1
.end_amdhsa_kernel
```
